```python
import torch

def _softmax(x, axis=-1):
    return torch.softmax(x, dim=axis)
def _gelu(x):
    return torch.nn.functional.gelu(x, approximate="tanh")
def _silu(x):
    return torch.nn.functional.silu(x)
def _sigmoid(x):
    return torch.sigmoid(x)
def _layernorm(x, axis=-1, eps=1e-5):
    m = x.mean(dim=axis, keepdim=True)
    v = x.var(dim=axis, keepdim=True, unbiased=False)
    return (x - m) / torch.sqrt(v + eps)
def _scatter_add(tgt, idx, src, axis=0):
    return tgt.clone().index_add_(axis, idx, src)
def _segment_sum(src, seg, n):
    out = torch.zeros((n,) + src.shape[1:], dtype=src.dtype)
    return out.index_add_(0, seg, src)
def _pad(x, pw):
    flat = tuple(v for pair in reversed(pw) for v in pair)
    return torch.nn.functional.pad(x, flat)

kernel_name = 'recurrent_scan__grouped_kv_mqa__mixer_channel_mlp__prompt'

def setup_inputs():

    _w = (lambda a: (lambda t: t.to(torch.bfloat16) if t.is_floating_point() else t)(torch.as_tensor(a)))
    def _A_setup():
        B, S, D, H = 1, 2048, 512, 32
        Dh = D // H
        return {
            "x": _w((lambda *s: torch.randn(*s, dtype=torch.bfloat16) * 0.05)(B, S, D)),
            "wq": _w((lambda *s: torch.randn(*s, dtype=torch.bfloat16) * 0.05)(D, H * Dh)),
            "wk": _w((lambda *s: torch.randn(*s, dtype=torch.bfloat16) * 0.05)(D, Dh)),
            "wv": _w((lambda *s: torch.randn(*s, dtype=torch.bfloat16) * 0.05)(D, Dh)),
            "wo": _w((lambda *s: torch.randn(*s, dtype=torch.bfloat16) * 0.05)(H * Dh, D)),
        }
    _A_in = _A_setup()

    def _B_setup():
        B, S, D, F = 1, 2048, 512, 1376
        return {
            "x": _w((lambda *s: torch.randn(*s, dtype=torch.bfloat16) * 0.05)(B, S, D)),
            "w1": _w((lambda *s: torch.randn(*s, dtype=torch.bfloat16) * 3.2)(D, F) * (D ** -0.5)),
            "b1": _w((lambda *s: torch.randn(*s, dtype=torch.bfloat16) * 1.6)(F)),
            "w2": _w((lambda *s: torch.randn(*s, dtype=torch.bfloat16) * 0.05)(F, D) * (F ** -0.5)),
            "b2": _w((lambda *s: torch.randn(*s, dtype=torch.bfloat16) * 0.05)(D)),
        }
    _B_in = _B_setup()

    return {
        "A_x": _A_in["x"],
        "A_wq": _A_in["wq"],
        "A_wk": _A_in["wk"],
        "A_wv": _A_in["wv"],
        "A_wo": _A_in["wo"],
        "B_x": _B_in["x"],
        "B_w1": _B_in["w1"],
        "B_b1": _B_in["b1"],
        "B_w2": _B_in["w2"],
        "B_b2": _B_in["b2"],
    }

def reference(A_x, A_wq, A_wk, A_wv, A_wo, B_x, B_w1, B_b1, B_w2, B_b2):
    def _A_ref(x, wq, wk, wv, wo):
        B, S, D = x.shape
        H = 32
        Dh = D // H
        q = (lambda x, *d: x.permute(*d))((x @ wq).reshape(B, S, H, Dh), 0, 2, 1, 3)
        k = x @ wk
        v = x @ wv
        scores = torch.einsum("bhqd,bkd->bhqk", q, k) * (Dh ** -0.5)
        p = _softmax(scores, axis=-1)
        o = torch.einsum("bhqk,bkd->bhqd", p, v)
        return (lambda x, *d: x.permute(*d))(o, 0, 2, 1, 3).reshape(B, S, H * Dh) @ wo

    def _B_ref(x, w1, b1, w2, b2):
        y = _layernorm(x, axis=-1)
        h = _gelu(torch.einsum("bsd,df->bsf", y, w1) + b1)
        return torch.einsum("bsf,fd->bsd", h, w2) + b2

    x = A_x
    xn = _layernorm(x, axis=-1)
    s = _A_ref(xn, A_wq, A_wk, A_wv, A_wo)
    g = _silu(_B_ref(xn, B_w1, B_b1, B_w2, B_b2))
    return x + s * g
```

```asm
; @launch grid=(256,1,1) block=(512,1,1) lds=163840
.amdgcn_target "amdgcn-amd-amdhsa--gfx950"
.text
.globl recurrent_scan__grouped_kv_mqa__mixer_channel_mlp__prompt_kernel
.p2align 8
.type recurrent_scan__grouped_kv_mqa__mixer_channel_mlp__prompt_kernel,@function
recurrent_scan__grouped_kv_mqa__mixer_channel_mlp__prompt_kernel:
    s_cmp_ge_u32 s2, 256
    s_cbranch_scc1 L_end
    s_load_dwordx16 s[16:31], s[0:1], 0
    s_load_dwordx8 s[32:39], s[0:1], 64
    s_load_dwordx2 s[40:41], s[0:1], 96
    v_lshrrev_b32 v1, 6, v0
    v_and_b32 v0, 63, v0
    v_readfirstlane_b32 s3, v1
    s_bfe_u32 s4, s2, 0x20001
    s_lshl_b32 s4, s4, 3
    s_bfe_u32 s6, s2, 0x30003
    s_add_u32 s4, s4, s6
    s_and_b32 s6, s2, 1
    s_lshl_b32 s6, s6, 2
    s_lshr_b32 s7, s2, 6
    s_add_u32 s6, s6, s7
    s_lshl_b32 s6, s6, 2
    s_lshr_b32 s5, 0x26543710, s6
    s_and_b32 s5, s5, 7
    s_lshr_b32 s75, s2, 3
    s_cmp_eq_u32 s5, 7
    s_cselect_b32 s6, 4, 0
    s_xor_b32 s42, s3, s6
    v_lshrrev_b32 v2, 3, v0
    v_and_b32 v3, 7, v0
    s_and_b32 s7, s3, 1
    s_lshl_b32 s7, s7, 2
    v_lshrrev_b32 v4, 4, v0
    v_or_b32 v4, s7, v4
    v_xor_b32 v4, v4, v3
    v_lshlrev_b32 v4, 4, v4
    v_lshl_add_u32 v4, v2, 10, v4
    s_lshl_b32 s6, s4, 16
    s_lshl_b32 s7, s3, 13
    s_add_u32 s6, s6, s7
    v_lshlrev_b32 v5, 4, v0
    v_lshrrev_b32 v6, 2, v0
    v_and_b32 v7, 3, v0
    s_mov_b32 m0, s7
    s_waitcnt lgkmcnt(0)
    s_mov_b32 s44, s16
    s_mov_b32 s45, s17
    s_mov_b32 s46, 2097152
    s_mov_b32 s47, 0x00020000
    buffer_load_dwordx4 v4, s[44:47], s6 offen offset:0 nt lds
    s_add_u32 m0, s7, 896
    s_nop 0
    buffer_load_dwordx4 v4, s[44:47], s6 offen offset:128 nt lds
    s_add_u32 m0, s7, 1792
    s_nop 0
    buffer_load_dwordx4 v4, s[44:47], s6 offen offset:256 nt lds
    s_add_u32 m0, s7, 2688
    s_nop 0
    buffer_load_dwordx4 v4, s[44:47], s6 offen offset:384 nt lds
    s_add_u32 m0, s7, 3584
    s_nop 0
    buffer_load_dwordx4 v4, s[44:47], s6 offen offset:512 nt lds
    s_add_u32 m0, s7, 4480
    s_nop 0
    buffer_load_dwordx4 v4, s[44:47], s6 offen offset:640 nt lds
    s_add_u32 m0, s7, 5376
    s_nop 0
    buffer_load_dwordx4 v4, s[44:47], s6 offen offset:768 nt lds
    s_add_u32 m0, s7, 6272
    s_nop 0
    buffer_load_dwordx4 v4, s[44:47], s6 offen offset:896 nt lds
    s_mov_b32 s56, s40
    s_mov_b32 s57, s41
    s_mov_b32 s58, 16777216
    s_mov_b32 s59, 0x00020000
    s_mul_i32 s9, s5, 6
    s_add_u32 s9, s9, s42
    s_cmp_gt_u32 s5, 3
    s_cselect_b32 s10, 3, 2
    s_sub_u32 s9, s9, s10
    s_max_i32 s9, s9, 0
    s_cmp_lt_u32 s9, 43
    s_cselect_b32 s43, 0, 1
    s_lshl_b32 s10, s5, 3
    s_add_u32 s10, s10, s42
    s_cmp_eq_u32 s10, 31
    s_cselect_b32 s43, 2, s43
    s_lshl_b32 s10, s5, 1
    s_add_u32 s10, s10, s42
    s_cmp_lt_u32 s42, 2
    s_cselect_b32 s48, s18, s28
    s_cselect_b32 s49, s19, s29
    s_mov_b32 s50, 1409024
    s_cselect_b32 s50, 524288, s50
    s_mov_b32 s51, 0x00020000
    s_mov_b32 s11, 2752
    s_cselect_b32 s11, 1024, s11
    s_cselect_b32 s12, s10, s9
    s_lshl_b32 s12, s12, 6
    s_lshl_b32 s13, s11, 4
    v_mul_u32_u24 v8, s11, v6
    v_lshl_add_u32 v8, v7, 4, v8
    s_cmp_eq_u32 s43, 0
    s_cbranch_scc1 L_stdw
    s_cmp_lt_u32 s42, 6
    s_cselect_b32 s48, s20, s22
    s_cselect_b32 s49, s21, s23
    s_cmp_eq_u32 s43, 2
    s_cselect_b32 s50, 0, 16384
    s_and_b32 s12, s42, 1
    s_lshl_b32 s12, s12, 13
    s_mov_b32 s13, 1024
    v_mov_b32 v8, v5
    s_nop 1
L_stdw:
    s_mul_i32 s14, s3, 10240
    s_add_u32 s14, s14, 66048
    s_cmp_lg_u32 s3, 7
    s_cbranch_scc1 L_notouch0
    s_sub_u32 s10, s2, 64
    s_cmp_lt_u32 s2, 64
    s_cselect_b32 s52, s18, s28
    s_cselect_b32 s53, s19, s29
    s_mov_b32 s54, 704512
    s_cselect_b32 s54, 262144, s54
    s_mov_b32 s55, 0x00020000
    s_cselect_b32 s8, s2, s10
    s_mov_b32 s10, 0
    s_cselect_b32 s10, 0, s10
    s_lshl_b32 s8, s8, 12
    s_add_u32 s8, s8, s10
    v_and_b32 v208, 31, v0
    v_lshlrev_b32 v208, 7, v208
    buffer_load_dword v209, v208, s[52:55], s8 offen
    s_cmp_lg_u32 s2, 255
    s_cbranch_scc1 L_notouch0
    s_mov_b32 s52, s30
    s_mov_b32 s53, s31
    s_mov_b32 s54, 2752
    s_mov_b32 s55, 0x00020000
    buffer_load_dword v210, v208, s[52:55], 0 offen
    s_mov_b32 s52, s34
    s_mov_b32 s53, s35
    s_mov_b32 s54, 1024
    s_mov_b32 s55, 0x00020000
    buffer_load_dword v211, v208, s[52:55], 0 offen
L_notouch0:
    s_barrier
    v_mov_b32 v1, 131072
    buffer_load_dword v1, v1, s[56:59], 0 offen sc1
    s_add_u32 m0, s14, 0
    s_add_u32 s74, s12, 0
    s_add_u32 s12, s12, s13
    buffer_load_dwordx4 v8, s[48:51], s74 offen lds
    v_lshlrev_b32 v9, 10, v6
    v_lshl_add_u32 v9, v7, 4, v9
    s_lshl_b32 s76, s4, 3
    s_add_u32 s76, s76, s3
    s_sub_u32 s77, s76, 172
    s_cmp_lt_u32 s76, 172
    s_cselect_b32 s60, s32, s24
    s_cselect_b32 s61, s33, s25
    s_mov_b32 s62, 524288
    s_cselect_b32 s62, 1409024, s62
    s_mov_b32 s63, 0x00020000
    s_cselect_b32 s77, s76, s77
    s_mov_b32 s78, 65536
    s_cselect_b32 s78, 180224, s78
    s_mov_b32 s79, 12582912
    s_cselect_b32 s79, 10485760, s79
    s_lshr_b32 s80, s77, 1
    s_and_b32 s81, s77, 1
    s_lshl_b32 s82, s80, 14
    s_lshl_b32 s83, s81, 6
    s_add_u32 s82, s82, s83
    s_lshl_b32 s83, s5, 7
    s_add_u32 s82, s82, s83
    s_mul_i32 s83, s5, s78
    s_add_u32 s79, s79, s83
    s_lshl_b32 s83, s77, 10
    s_add_u32 s79, s79, s83
    s_cmp_lt_u32 s76, 236
    s_cselect_b32 s79, s79, 16777216
    v_add_u32 v11, s7, v5
    s_lshl_b32 s8, s3, 5
    s_add_u32 s8, s8, 156160
    v_lshl_add_u32 v12, v2, 2, s8
    v_and_b32 v13, 31, v0
    v_lshrrev_b32 v14, 5, v0
    v_bfe_u32 v52, v0, 1, 3
    v_xor_b32 v52, v52, v14
    v_bfe_u32 v53, v0, 3, 2
    v_lshlrev_b32 v53, 13, v53
    v_lshl_add_u32 v53, v3, 7, v53
    v_xor_b32 v15, 0, v52
    v_lshl_add_u32 v60, v15, 4, v53
    v_xor_b32 v15, 2, v52
    v_lshl_add_u32 v61, v15, 4, v53
    v_xor_b32 v15, 4, v52
    v_lshl_add_u32 v62, v15, 4, v53
    v_xor_b32 v15, 6, v52
    v_lshl_add_u32 v63, v15, 4, v53
    v_bfe_u32 v52, v0, 2, 2
    v_bfe_u32 v53, v0, 4, 1
    v_lshlrev_b32 v52, 6, v52
    v_lshl_add_u32 v52, v53, 5, v52
    v_add_u32 v52, s14, v52
    v_lshl_add_u32 v15, v7, 3, v52
    v_and_b32 v7, 1, v0
    v_bfe_u32 v6, v0, 1, 1
    v_lshl_add_u32 v7, v7, 4, v52
    v_lshl_add_u32 v7, v6, 3, v7
    v_lshl_add_u32 v7, v14, 8, v7
    v_lshl_add_u32 v6, v14, 9, v15
    v_lshlrev_b32 v57, 2, v13
    v_add_u32 v57, 156160, v57
    s_lshl_b32 s8, s3, 7
    s_add_u32 s8, s8, 157184
    v_and_b32 v52, 15, v0
    v_lshrrev_b32 v53, 4, v0
    v_lshlrev_b32 v54, 6, v52
    v_lshl_add_u32 v54, v53, 4, v54
    v_add_u32 v54, s8, v54
    v_mov_b32 v15, 0x40000
    v_cmp_gt_u32 vcc, 2, v52
    s_nop 1
    v_cndmask_b32 v54, v15, v54, vcc
    v_and_b32 v53, 1, v53
    v_cmp_eq_u32 vcc, v53, v52
    v_mov_b32 v15, 0x3f803f80
    s_nop 0
    v_cndmask_b32 v200, 0, v15, vcc
    v_cndmask_b32 v201, 0, v15, vcc
    v_cndmask_b32 v202, 0, v15, vcc
    v_cndmask_b32 v203, 0, v15, vcc
    v_lshl_add_u32 v55, v14, 4, s8
    v_lshlrev_b32 v10, 7, v13
    v_mov_b32 v15, 158208
    v_mov_b32 v52, 0
    ds_write_b32 v15, v52
    s_mov_b32 s72, 0x3f803f80
    s_mov_b32 s64, s30
    s_mov_b32 s65, s31
    s_mov_b32 s66, 2752
    s_mov_b32 s67, 0x00020000
    s_mul_i32 s8, s4, 180224
    s_add_u32 s8, s8, 4194304
    s_add_u32 s68, s40, s8
    s_addc_u32 s69, s41, 0
    s_mov_b32 s70, 176128
    s_mov_b32 s71, 0x00020000
    s_lshr_b32 s8, s3, 2
    s_mul_i32 s8, s8, 10240
    s_add_u32 s8, s8, 66048
    v_add_u32 v244, s8, v5
    v_and_b32 v52, 15, v0
    v_lshlrev_b32 v52, 4, v52
    v_lshl_add_u32 v52, v14, 8, v52
    v_add_u32 v245, 1024, v52
    v_add_u32 v246, 1536, v52
    v_mov_b32 v53, 2048
    v_cmp_eq_u32 vcc, 16, v13
    s_nop 1
    v_cndmask_b32 v245, v245, v53, vcc
    v_cndmask_b32 v246, v246, v53, vcc
    v_mov_b32 v53, 0x40000
    v_cmp_lt_u32 vcc, 16, v13
    s_nop 1
    v_cndmask_b32 v245, v245, v53, vcc
    v_cndmask_b32 v246, v246, v53, vcc
    v_add_u32 v245, s8, v245
    v_add_u32 v246, s8, v246
    s_and_b32 s8, s3, 3
    s_lshl_b32 s8, s8, 1
    s_lshr_b32 s10, s3, 2
    s_add_u32 s8, s8, s10
    s_lshl_b32 s8, s8, 10
    s_add_u32 s8, s8, 147968
    v_add_u32 v247, s8, v5
    v_mov_b32 v212, 0
    v_mov_b32 v213, 0
    v_mov_b32 v214, 0
    v_mov_b32 v215, 0
    v_mov_b32 v216, 0
    v_mov_b32 v217, 0
    v_mov_b32 v218, 0
    v_mov_b32 v219, 0
    v_mov_b32 v220, 0
    v_mov_b32 v221, 0
    v_mov_b32 v222, 0
    v_mov_b32 v223, 0
    v_mov_b32 v224, 0
    v_mov_b32 v225, 0
    v_mov_b32 v226, 0
    v_mov_b32 v227, 0
    v_mov_b32 v228, 0
    v_mov_b32 v229, 0
    v_mov_b32 v230, 0
    v_mov_b32 v231, 0
    v_mov_b32 v232, 0
    v_mov_b32 v233, 0
    v_mov_b32 v234, 0
    v_mov_b32 v235, 0
    v_mov_b32 v236, 0
    v_mov_b32 v237, 0
    v_mov_b32 v238, 0
    v_mov_b32 v239, 0
    v_mov_b32 v240, 0
    v_mov_b32 v241, 0
    v_mov_b32 v242, 0
    v_mov_b32 v243, 0
    v_lshl_add_u32 v248, v13, 3, s5
    s_lshl_b32 s8, s4, 3
    v_add_u32 v52, s8, v3
    v_cmp_eq_u32 vcc, 0, v14
    s_nop 1
    v_cndmask_b32 v248, v52, v248, vcc
    v_lshlrev_b32 v248, 7, v248
    s_lshr_b32 s8, s3, 1
    s_lshl_b32 s8, s8, 14
    s_and_b32 s10, s3, 1
    s_lshl_b32 s10, s10, 13
    s_add_u32 s8, s8, s10
    s_add_u32 s8, s8, 66048
    v_and_b32 v52, 15, v0
    v_lshlrev_b32 v53, 1, v14
    v_xor_b32 v52, v52, v53
    v_lshlrev_b32 v52, 4, v52
    v_lshl_add_u32 v52, v13, 8, v52
    v_add_u32 v249, s8, v52
    s_lshl_b32 s8, s3, 3
    v_add_u32 v52, s8, v2
    v_and_b32 v53, 15, v52
    v_lshlrev_b32 v250, 1, v3
    v_xor_b32 v53, v53, v250
    v_lshlrev_b32 v53, 4, v53
    v_lshl_add_u32 v250, v52, 8, v53
    v_add_u32 v250, 66048, v250
    v_lshlrev_b32 v251, 10, v2
    v_lshl_add_u32 v251, v3, 4, v251
    v_xor_b32 v252, v3, v14
    v_lshlrev_b32 v252, 4, v252
    v_lshl_add_u32 v252, v13, 7, v252
    s_lshl_b32 s8, s3, 13
    v_add_u32 v252, s8, v252
    v_xor_b32 v253, v3, v2
    v_lshlrev_b32 v253, 4, v253
    v_lshl_add_u32 v253, v2, 7, v253
    s_lshl_b32 s8, s3, 10
    v_add_u32 v253, s8, v253
    s_waitcnt vmcnt(9)
    ds_read_b128 v[16:19], v11 offset:0
    s_waitcnt vmcnt(8)
    ds_read_b128 v[20:23], v11 offset:1024
    s_waitcnt vmcnt(7)
    ds_read_b128 v[24:27], v11 offset:2048
    s_waitcnt vmcnt(6)
    ds_read_b128 v[28:31], v11 offset:3072
    s_waitcnt vmcnt(5)
    ds_read_b128 v[32:35], v11 offset:4096
    s_waitcnt vmcnt(4)
    ds_read_b128 v[36:39], v11 offset:5120
    s_waitcnt vmcnt(3)
    ds_read_b128 v[40:43], v11 offset:6144
    s_waitcnt vmcnt(2)
    ds_read_b128 v[44:47], v11 offset:7168
    s_waitcnt lgkmcnt(7)
    v_dot2_f32_bf16 v48, v16, s72, 0
    v_dot2_f32_bf16 v49, v16, v16, 0
    v_dot2_f32_bf16 v48, v17, s72, v48
    v_dot2_f32_bf16 v49, v17, v17, v49
    v_dot2_f32_bf16 v48, v18, s72, v48
    v_dot2_f32_bf16 v49, v18, v18, v49
    v_dot2_f32_bf16 v48, v19, s72, v48
    v_dot2_f32_bf16 v49, v19, v19, v49
    s_waitcnt lgkmcnt(6)
    v_dot2_f32_bf16 v48, v20, s72, v48
    v_dot2_f32_bf16 v49, v20, v20, v49
    v_dot2_f32_bf16 v48, v21, s72, v48
    v_dot2_f32_bf16 v49, v21, v21, v49
    v_dot2_f32_bf16 v48, v22, s72, v48
    v_dot2_f32_bf16 v49, v22, v22, v49
    v_dot2_f32_bf16 v48, v23, s72, v48
    v_dot2_f32_bf16 v49, v23, v23, v49
    s_waitcnt lgkmcnt(5)
    v_dot2_f32_bf16 v48, v24, s72, v48
    v_dot2_f32_bf16 v49, v24, v24, v49
    v_dot2_f32_bf16 v48, v25, s72, v48
    v_dot2_f32_bf16 v49, v25, v25, v49
    v_dot2_f32_bf16 v48, v26, s72, v48
    v_dot2_f32_bf16 v49, v26, v26, v49
    v_dot2_f32_bf16 v48, v27, s72, v48
    v_dot2_f32_bf16 v49, v27, v27, v49
    s_waitcnt lgkmcnt(4)
    v_dot2_f32_bf16 v48, v28, s72, v48
    v_dot2_f32_bf16 v49, v28, v28, v49
    v_dot2_f32_bf16 v48, v29, s72, v48
    v_dot2_f32_bf16 v49, v29, v29, v49
    v_dot2_f32_bf16 v48, v30, s72, v48
    v_dot2_f32_bf16 v49, v30, v30, v49
    v_dot2_f32_bf16 v48, v31, s72, v48
    v_dot2_f32_bf16 v49, v31, v31, v49
    s_waitcnt lgkmcnt(3)
    v_dot2_f32_bf16 v48, v32, s72, v48
    v_dot2_f32_bf16 v49, v32, v32, v49
    v_dot2_f32_bf16 v48, v33, s72, v48
    v_dot2_f32_bf16 v49, v33, v33, v49
    v_dot2_f32_bf16 v48, v34, s72, v48
    v_dot2_f32_bf16 v49, v34, v34, v49
    v_dot2_f32_bf16 v48, v35, s72, v48
    v_dot2_f32_bf16 v49, v35, v35, v49
    s_waitcnt lgkmcnt(2)
    v_dot2_f32_bf16 v48, v36, s72, v48
    v_dot2_f32_bf16 v49, v36, v36, v49
    v_dot2_f32_bf16 v48, v37, s72, v48
    v_dot2_f32_bf16 v49, v37, v37, v49
    v_dot2_f32_bf16 v48, v38, s72, v48
    v_dot2_f32_bf16 v49, v38, v38, v49
    v_dot2_f32_bf16 v48, v39, s72, v48
    v_dot2_f32_bf16 v49, v39, v39, v49
    s_waitcnt lgkmcnt(1)
    v_dot2_f32_bf16 v48, v40, s72, v48
    v_dot2_f32_bf16 v49, v40, v40, v49
    v_dot2_f32_bf16 v48, v41, s72, v48
    v_dot2_f32_bf16 v49, v41, v41, v49
    v_dot2_f32_bf16 v48, v42, s72, v48
    v_dot2_f32_bf16 v49, v42, v42, v49
    v_dot2_f32_bf16 v48, v43, s72, v48
    v_dot2_f32_bf16 v49, v43, v43, v49
    s_waitcnt lgkmcnt(0)
    v_dot2_f32_bf16 v48, v44, s72, v48
    v_dot2_f32_bf16 v49, v44, v44, v49
    v_dot2_f32_bf16 v48, v45, s72, v48
    v_dot2_f32_bf16 v49, v45, v45, v49
    v_dot2_f32_bf16 v48, v46, s72, v48
    v_dot2_f32_bf16 v49, v46, v46, v49
    v_dot2_f32_bf16 v48, v47, s72, v48
    v_dot2_f32_bf16 v49, v47, v47, v49
    s_nop 1
    v_add_f32_dpp v48, v48, v48 quad_perm:[1,0,3,2] row_mask:0xf bank_mask:0xf
    v_add_f32_dpp v49, v49, v49 quad_perm:[1,0,3,2] row_mask:0xf bank_mask:0xf
    s_nop 0
    v_add_f32_dpp v48, v48, v48 quad_perm:[2,3,0,1] row_mask:0xf bank_mask:0xf
    v_add_f32_dpp v49, v49, v49 quad_perm:[2,3,0,1] row_mask:0xf bank_mask:0xf
    s_nop 0
    v_add_f32_dpp v48, v48, v48 row_half_mirror row_mask:0xf bank_mask:0xf
    v_add_f32_dpp v49, v49, v49 row_half_mirror row_mask:0xf bank_mask:0xf
    v_mul_f32 v48, 0xbb000000, v48
    v_mul_f32 v49, 0x3b000000, v49
    v_fma_f32 v49, -v48, v48, v49
    v_max_f32 v49, 0, v49
    v_add_f32 v50, 0x3727c5ac, v49
    v_rsq_f32 v50, v50
    s_nop 0
    v_mul_f32 v51, v49, v50
    v_fmaak_f32 v51, v51, v50, 0x3727c5ac
    v_rsq_f32 v51, v51
    s_nop 0
    v_mul_f32 v51, v51, v50
    ds_write2_b32 v12, v50, v51 offset0:0 offset1:64
    ds_write_b32 v12, v48 offset:512
    s_add_u32 m0, s14, 1024
    s_add_u32 s74, s12, 0
    s_add_u32 s12, s12, s13
    buffer_load_dwordx4 v8, s[48:51], s74 offen lds
    s_add_u32 m0, s14, 2048
    s_add_u32 s74, s12, 0
    s_add_u32 s12, s12, s13
    buffer_load_dwordx4 v8, s[48:51], s74 offen lds
    s_add_u32 m0, s14, 3072
    s_add_u32 s74, s12, 0
    s_add_u32 s12, s12, s13
    buffer_load_dwordx4 v8, s[48:51], s74 offen lds
    s_add_u32 m0, s14, 4096
    s_add_u32 s74, s12, 0
    s_add_u32 s12, s12, s13
    buffer_load_dwordx4 v8, s[48:51], s74 offen lds
    s_add_u32 m0, s14, 5120
    s_add_u32 s74, s12, 0
    s_add_u32 s12, s12, s13
    buffer_load_dwordx4 v8, s[48:51], s74 offen lds
    s_add_u32 m0, s14, 6144
    s_add_u32 s74, s12, 0
    s_add_u32 s12, s12, s13
    buffer_load_dwordx4 v8, s[48:51], s74 offen lds
    s_add_u32 m0, s14, 7168
    s_add_u32 s74, s12, 0
    s_add_u32 s12, s12, s13
    buffer_load_dwordx4 v8, s[48:51], s74 offen lds
    s_cmp_lg_u32 s43, 1
    s_cbranch_scc1 L_nokvw
    s_waitcnt vmcnt(0)
L_nokvw:
    s_waitcnt lgkmcnt(0)
    s_barrier
    s_add_u32 m0, s14, 8192
    s_add_u32 s74, s12, 0
    s_add_u32 s12, s12, s13
    buffer_load_dwordx4 v8, s[48:51], s74 offen lds
    s_add_u32 m0, s14, 9216
    s_add_u32 s74, s12, 0
    s_add_u32 s12, s12, s13
    buffer_load_dwordx4 v8, s[48:51], s74 offen lds
    s_cmp_lg_u32 s3, 3
    s_cbranch_scc1 L_notouch1
    s_sub_u32 s10, s2, 64
    s_cmp_lt_u32 s2, 64
    s_cselect_b32 s52, s18, s28
    s_cselect_b32 s53, s19, s29
    s_mov_b32 s54, 1409024
    s_cselect_b32 s54, 524288, s54
    s_mov_b32 s55, 0x00020000
    s_cselect_b32 s8, s2, s10
    s_mov_b32 s10, 704512
    s_cselect_b32 s10, 262144, s10
    s_lshl_b32 s8, s8, 12
    s_add_u32 s8, s8, s10
    v_and_b32 v208, 31, v0
    v_lshlrev_b32 v208, 7, v208
    buffer_load_dword v209, v208, s[52:55], s8 offen
    s_nop 0
L_notouch1:
    s_cmp_eq_u32 s43, 0
    s_cbranch_scc0 L_spare
    s_cmp_lg_u32 s5, 7
    s_cbranch_scc1 L_nohold
    s_barrier
L_nohold:
    s_waitcnt vmcnt(9)
    ds_read_b64_tr_b16 v[96:97], v6 offset:0
    ds_read_b64_tr_b16 v[98:99], v6 offset:256
    ds_read_b128 v[104:107], v60 offset:0
    ds_read_b128 v[108:111], v60 offset:32768
    s_waitcnt vmcnt(8)
    ds_read_b64_tr_b16 v[100:101], v6 offset:1024
    ds_read_b64_tr_b16 v[102:103], v6 offset:1280
    ds_read_b128 v[112:115], v61 offset:0
    ds_read_b128 v[116:119], v61 offset:32768
    s_waitcnt lgkmcnt(6)
    v_mfma_f32_16x16x32_bf16 v[204:207], v[96:99], v[200:203], 0
    s_waitcnt lgkmcnt(5)
    v_mfma_f32_32x32x16_bf16 v[64:79], v[96:99], v[104:107], 0
    s_add_u32 m0, s14, 0
    s_add_u32 s74, s12, 0
    s_add_u32 s12, s12, s13
    buffer_load_dwordx4 v8, s[48:51], s74 offen lds
    s_waitcnt lgkmcnt(4)
    v_mfma_f32_32x32x16_bf16 v[80:95], v[96:99], v[108:111], 0
    s_waitcnt vmcnt(8)
    ds_read_b64_tr_b16 v[96:97], v6 offset:2048
    ds_read_b64_tr_b16 v[98:99], v6 offset:2304
    ds_read_b128 v[104:107], v62 offset:0
    ds_read_b128 v[108:111], v62 offset:32768
    s_waitcnt lgkmcnt(6)
    v_mfma_f32_16x16x32_bf16 v[204:207], v[100:103], v[200:203], v[204:207]
    s_waitcnt lgkmcnt(5)
    v_mfma_f32_32x32x16_bf16 v[64:79], v[100:103], v[112:115], v[64:79]
    s_add_u32 m0, s14, 1024
    s_add_u32 s74, s12, 0
    s_add_u32 s12, s12, s13
    buffer_load_dwordx4 v8, s[48:51], s74 offen lds
    s_waitcnt lgkmcnt(4)
    v_mfma_f32_32x32x16_bf16 v[80:95], v[100:103], v[116:119], v[80:95]
    s_waitcnt vmcnt(8)
    ds_read_b64_tr_b16 v[100:101], v6 offset:3072
    ds_read_b64_tr_b16 v[102:103], v6 offset:3328
    ds_read_b128 v[112:115], v63 offset:0
    ds_read_b128 v[116:119], v63 offset:32768
    s_waitcnt lgkmcnt(6)
    v_mfma_f32_16x16x32_bf16 v[204:207], v[96:99], v[200:203], v[204:207]
    s_waitcnt lgkmcnt(5)
    v_mfma_f32_32x32x16_bf16 v[64:79], v[96:99], v[104:107], v[64:79]
    s_add_u32 m0, s14, 2048
    s_add_u32 s74, s12, 0
    s_add_u32 s12, s12, s13
    buffer_load_dwordx4 v8, s[48:51], s74 offen lds
    s_waitcnt lgkmcnt(4)
    v_mfma_f32_32x32x16_bf16 v[80:95], v[96:99], v[108:111], v[80:95]
    s_waitcnt vmcnt(8)
    ds_read_b64_tr_b16 v[96:97], v6 offset:4096
    ds_read_b64_tr_b16 v[98:99], v6 offset:4352
    ds_read_b128 v[104:107], v60 offset:1024
    ds_read_b128 v[108:111], v60 offset:33792
    s_waitcnt lgkmcnt(6)
    v_mfma_f32_16x16x32_bf16 v[204:207], v[100:103], v[200:203], v[204:207]
    s_waitcnt lgkmcnt(5)
    v_mfma_f32_32x32x16_bf16 v[64:79], v[100:103], v[112:115], v[64:79]
    s_add_u32 m0, s14, 3072
    s_add_u32 s74, s12, 0
    s_add_u32 s12, s12, s13
    buffer_load_dwordx4 v8, s[48:51], s74 offen lds
    s_waitcnt lgkmcnt(4)
    v_mfma_f32_32x32x16_bf16 v[80:95], v[100:103], v[116:119], v[80:95]
    s_waitcnt vmcnt(8)
    ds_read_b64_tr_b16 v[100:101], v6 offset:5120
    ds_read_b64_tr_b16 v[102:103], v6 offset:5376
    ds_read_b128 v[112:115], v61 offset:1024
    ds_read_b128 v[116:119], v61 offset:33792
    s_waitcnt lgkmcnt(6)
    v_mfma_f32_16x16x32_bf16 v[204:207], v[96:99], v[200:203], v[204:207]
    s_waitcnt lgkmcnt(5)
    v_mfma_f32_32x32x16_bf16 v[64:79], v[96:99], v[104:107], v[64:79]
    s_add_u32 m0, s14, 4096
    s_add_u32 s74, s12, 0
    s_add_u32 s12, s12, s13
    buffer_load_dwordx4 v8, s[48:51], s74 offen lds
    s_waitcnt lgkmcnt(4)
    v_mfma_f32_32x32x16_bf16 v[80:95], v[96:99], v[108:111], v[80:95]
    s_waitcnt vmcnt(8)
    ds_read_b64_tr_b16 v[96:97], v6 offset:6144
    ds_read_b64_tr_b16 v[98:99], v6 offset:6400
    ds_read_b128 v[104:107], v62 offset:1024
    ds_read_b128 v[108:111], v62 offset:33792
    s_waitcnt lgkmcnt(6)
    v_mfma_f32_16x16x32_bf16 v[204:207], v[100:103], v[200:203], v[204:207]
    s_waitcnt lgkmcnt(5)
    v_mfma_f32_32x32x16_bf16 v[64:79], v[100:103], v[112:115], v[64:79]
    s_add_u32 m0, s14, 5120
    s_add_u32 s74, s12, 0
    s_add_u32 s12, s12, s13
    buffer_load_dwordx4 v8, s[48:51], s74 offen lds
    s_waitcnt lgkmcnt(4)
    v_mfma_f32_32x32x16_bf16 v[80:95], v[100:103], v[116:119], v[80:95]
    s_waitcnt vmcnt(8)
    ds_read_b64_tr_b16 v[100:101], v6 offset:7168
    ds_read_b64_tr_b16 v[102:103], v6 offset:7424
    ds_read_b128 v[112:115], v63 offset:1024
    ds_read_b128 v[116:119], v63 offset:33792
    s_waitcnt lgkmcnt(6)
    v_mfma_f32_16x16x32_bf16 v[204:207], v[96:99], v[200:203], v[204:207]
    s_waitcnt lgkmcnt(5)
    v_mfma_f32_32x32x16_bf16 v[64:79], v[96:99], v[104:107], v[64:79]
    s_add_u32 m0, s14, 6144
    s_add_u32 s74, s12, 0
    s_add_u32 s12, s12, s13
    buffer_load_dwordx4 v8, s[48:51], s74 offen lds
    s_waitcnt lgkmcnt(4)
    v_mfma_f32_32x32x16_bf16 v[80:95], v[96:99], v[108:111], v[80:95]
    s_waitcnt vmcnt(8)
    ds_read_b64_tr_b16 v[96:97], v6 offset:8192
    ds_read_b64_tr_b16 v[98:99], v6 offset:8448
    ds_read_b128 v[104:107], v60 offset:2048
    ds_read_b128 v[108:111], v60 offset:34816
    s_waitcnt lgkmcnt(6)
    v_mfma_f32_16x16x32_bf16 v[204:207], v[100:103], v[200:203], v[204:207]
    s_waitcnt lgkmcnt(5)
    v_mfma_f32_32x32x16_bf16 v[64:79], v[100:103], v[112:115], v[64:79]
    s_add_u32 m0, s14, 7168
    s_add_u32 s74, s12, 0
    s_add_u32 s12, s12, s13
    buffer_load_dwordx4 v8, s[48:51], s74 offen lds
    s_waitcnt lgkmcnt(4)
    v_mfma_f32_32x32x16_bf16 v[80:95], v[100:103], v[116:119], v[80:95]
    s_waitcnt vmcnt(8)
    ds_read_b64_tr_b16 v[100:101], v6 offset:9216
    ds_read_b64_tr_b16 v[102:103], v6 offset:9472
    ds_read_b128 v[112:115], v61 offset:2048
    ds_read_b128 v[116:119], v61 offset:34816
    s_waitcnt lgkmcnt(6)
    v_mfma_f32_16x16x32_bf16 v[204:207], v[96:99], v[200:203], v[204:207]
    s_waitcnt lgkmcnt(5)
    v_mfma_f32_32x32x16_bf16 v[64:79], v[96:99], v[104:107], v[64:79]
    s_add_u32 m0, s14, 8192
    s_add_u32 s74, s12, 0
    s_add_u32 s12, s12, s13
    buffer_load_dwordx4 v8, s[48:51], s74 offen lds
    s_waitcnt lgkmcnt(4)
    v_mfma_f32_32x32x16_bf16 v[80:95], v[96:99], v[108:111], v[80:95]
    s_waitcnt vmcnt(8)
    ds_read_b64_tr_b16 v[96:97], v6 offset:0
    ds_read_b64_tr_b16 v[98:99], v6 offset:256
    ds_read_b128 v[104:107], v62 offset:2048
    ds_read_b128 v[108:111], v62 offset:34816
    s_waitcnt lgkmcnt(6)
    v_mfma_f32_16x16x32_bf16 v[204:207], v[100:103], v[200:203], v[204:207]
    s_waitcnt lgkmcnt(5)
    v_mfma_f32_32x32x16_bf16 v[64:79], v[100:103], v[112:115], v[64:79]
    s_add_u32 m0, s14, 9216
    s_add_u32 s74, s12, 0
    s_add_u32 s12, s12, s13
    buffer_load_dwordx4 v8, s[48:51], s74 offen lds
    s_waitcnt lgkmcnt(4)
    v_mfma_f32_32x32x16_bf16 v[80:95], v[100:103], v[116:119], v[80:95]
    s_waitcnt vmcnt(8)
    ds_read_b64_tr_b16 v[100:101], v6 offset:1024
    ds_read_b64_tr_b16 v[102:103], v6 offset:1280
    ds_read_b128 v[112:115], v63 offset:2048
    ds_read_b128 v[116:119], v63 offset:34816
    s_waitcnt lgkmcnt(6)
    v_mfma_f32_16x16x32_bf16 v[204:207], v[96:99], v[200:203], v[204:207]
    s_waitcnt lgkmcnt(5)
    v_mfma_f32_32x32x16_bf16 v[64:79], v[96:99], v[104:107], v[64:79]
    s_lshl_b32 s10, s9, 6
    v_lshlrev_b32 v56, 3, v14
    buffer_load_dwordx2 v[120:121], v56, s[64:67], s10 offen offset:0
    buffer_load_dwordx2 v[122:123], v56, s[64:67], s10 offen offset:16
    buffer_load_dwordx2 v[124:125], v56, s[64:67], s10 offen offset:32
    buffer_load_dwordx2 v[126:127], v56, s[64:67], s10 offen offset:48
    s_add_u32 m0, s14, 0
    s_add_u32 s74, s12, 0
    s_add_u32 s12, s12, s13
    buffer_load_dwordx4 v8, s[48:51], s74 offen lds
    s_waitcnt lgkmcnt(4)
    v_mfma_f32_32x32x16_bf16 v[80:95], v[96:99], v[108:111], v[80:95]
    s_waitcnt vmcnt(12)
    ds_read_b64_tr_b16 v[96:97], v6 offset:2048
    ds_read_b64_tr_b16 v[98:99], v6 offset:2304
    ds_read_b128 v[104:107], v60 offset:3072
    ds_read_b128 v[108:111], v60 offset:35840
    s_waitcnt lgkmcnt(6)
    v_mfma_f32_16x16x32_bf16 v[204:207], v[100:103], v[200:203], v[204:207]
    s_waitcnt lgkmcnt(5)
    v_mfma_f32_32x32x16_bf16 v[64:79], v[100:103], v[112:115], v[64:79]
    s_add_u32 m0, s14, 1024
    s_add_u32 s74, s12, 0
    s_add_u32 s12, s12, s13
    buffer_load_dwordx4 v8, s[48:51], s74 offen lds
    s_waitcnt lgkmcnt(4)
    v_mfma_f32_32x32x16_bf16 v[80:95], v[100:103], v[116:119], v[80:95]
    s_waitcnt vmcnt(12)
    ds_read_b64_tr_b16 v[100:101], v6 offset:3072
    ds_read_b64_tr_b16 v[102:103], v6 offset:3328
    ds_read_b128 v[112:115], v61 offset:3072
    ds_read_b128 v[116:119], v61 offset:35840
    s_waitcnt lgkmcnt(6)
    v_mfma_f32_16x16x32_bf16 v[204:207], v[96:99], v[200:203], v[204:207]
    s_waitcnt lgkmcnt(5)
    v_mfma_f32_32x32x16_bf16 v[64:79], v[96:99], v[104:107], v[64:79]
    v_readfirstlane_b32 s84, v1
    s_nop 1
    s_mul_i32 s84, s84, 0x9e3779b1
    s_add_u32 s84, s84, 0x7f4a7c15
    s_add_u32 m0, s14, 2048
    s_add_u32 s74, s12, 0
    s_add_u32 s12, s12, s13
    buffer_load_dwordx4 v8, s[48:51], s74 offen lds
    s_waitcnt lgkmcnt(4)
    v_mfma_f32_32x32x16_bf16 v[80:95], v[96:99], v[108:111], v[80:95]
    s_waitcnt vmcnt(12)
    ds_read_b64_tr_b16 v[96:97], v6 offset:4096
    ds_read_b64_tr_b16 v[98:99], v6 offset:4352
    ds_read_b128 v[104:107], v62 offset:3072
    ds_read_b128 v[108:111], v62 offset:35840
    s_waitcnt lgkmcnt(6)
    v_mfma_f32_16x16x32_bf16 v[204:207], v[100:103], v[200:203], v[204:207]
    s_waitcnt lgkmcnt(5)
    v_mfma_f32_32x32x16_bf16 v[64:79], v[100:103], v[112:115], v[64:79]
    s_add_u32 m0, s14, 3072
    s_add_u32 s74, s12, 0
    s_add_u32 s12, s12, s13
    buffer_load_dwordx4 v8, s[48:51], s74 offen lds
    s_waitcnt lgkmcnt(4)
    v_mfma_f32_32x32x16_bf16 v[80:95], v[100:103], v[116:119], v[80:95]
    s_waitcnt vmcnt(12)
    ds_read_b64_tr_b16 v[100:101], v6 offset:5120
    ds_read_b64_tr_b16 v[102:103], v6 offset:5376
    ds_read_b128 v[112:115], v63 offset:3072
    ds_read_b128 v[116:119], v63 offset:35840
    s_waitcnt lgkmcnt(6)
    v_mfma_f32_16x16x32_bf16 v[204:207], v[96:99], v[200:203], v[204:207]
    s_waitcnt lgkmcnt(5)
    v_mfma_f32_32x32x16_bf16 v[64:79], v[96:99], v[104:107], v[64:79]
    s_add_u32 m0, s14, 4096
    s_add_u32 s74, s12, 0
    s_add_u32 s12, s12, s13
    buffer_load_dwordx4 v8, s[48:51], s74 offen lds
    s_waitcnt lgkmcnt(4)
    v_mfma_f32_32x32x16_bf16 v[80:95], v[96:99], v[108:111], v[80:95]
    s_waitcnt vmcnt(12)
    ds_read_b64_tr_b16 v[96:97], v6 offset:6144
    ds_read_b64_tr_b16 v[98:99], v6 offset:6400
    ds_read_b128 v[104:107], v60 offset:4096
    ds_read_b128 v[108:111], v60 offset:36864
    s_waitcnt lgkmcnt(6)
    v_mfma_f32_16x16x32_bf16 v[204:207], v[100:103], v[200:203], v[204:207]
    s_waitcnt lgkmcnt(5)
    v_mfma_f32_32x32x16_bf16 v[64:79], v[100:103], v[112:115], v[64:79]
    s_add_u32 m0, s14, 5120
    s_add_u32 s74, s12, 0
    s_add_u32 s12, s12, s13
    buffer_load_dwordx4 v8, s[48:51], s74 offen lds
    s_waitcnt lgkmcnt(4)
    v_mfma_f32_32x32x16_bf16 v[80:95], v[100:103], v[116:119], v[80:95]
    s_waitcnt vmcnt(12)
    ds_read_b64_tr_b16 v[100:101], v6 offset:7168
    ds_read_b64_tr_b16 v[102:103], v6 offset:7424
    ds_read_b128 v[112:115], v61 offset:4096
    ds_read_b128 v[116:119], v61 offset:36864
    s_waitcnt lgkmcnt(6)
    v_mfma_f32_16x16x32_bf16 v[204:207], v[96:99], v[200:203], v[204:207]
    s_waitcnt lgkmcnt(5)
    v_mfma_f32_32x32x16_bf16 v[64:79], v[96:99], v[104:107], v[64:79]
    s_add_u32 m0, s14, 6144
    s_add_u32 s74, s12, 0
    s_add_u32 s12, s12, s13
    buffer_load_dwordx4 v8, s[48:51], s74 offen lds
    s_waitcnt lgkmcnt(4)
    v_mfma_f32_32x32x16_bf16 v[80:95], v[96:99], v[108:111], v[80:95]
    s_waitcnt vmcnt(12)
    ds_read_b64_tr_b16 v[96:97], v6 offset:8192
    ds_read_b64_tr_b16 v[98:99], v6 offset:8448
    ds_read_b128 v[104:107], v62 offset:4096
    ds_read_b128 v[108:111], v62 offset:36864
    s_waitcnt lgkmcnt(6)
    v_mfma_f32_16x16x32_bf16 v[204:207], v[100:103], v[200:203], v[204:207]
    s_waitcnt lgkmcnt(5)
    v_mfma_f32_32x32x16_bf16 v[64:79], v[100:103], v[112:115], v[64:79]
    s_add_u32 m0, s14, 7168
    s_add_u32 s74, s12, 0
    s_add_u32 s12, s12, s13
    buffer_load_dwordx4 v8, s[48:51], s74 offen lds
    s_waitcnt lgkmcnt(4)
    v_mfma_f32_32x32x16_bf16 v[80:95], v[100:103], v[116:119], v[80:95]
    s_waitcnt vmcnt(12)
    ds_read_b64_tr_b16 v[100:101], v6 offset:9216
    ds_read_b64_tr_b16 v[102:103], v6 offset:9472
    ds_read_b128 v[112:115], v63 offset:4096
    ds_read_b128 v[116:119], v63 offset:36864
    s_waitcnt lgkmcnt(6)
    v_mfma_f32_16x16x32_bf16 v[204:207], v[96:99], v[200:203], v[204:207]
    s_waitcnt lgkmcnt(5)
    v_mfma_f32_32x32x16_bf16 v[64:79], v[96:99], v[104:107], v[64:79]
    s_add_u32 m0, s14, 8192
    s_add_u32 s74, s12, 0
    s_add_u32 s12, s12, s13
    buffer_load_dwordx4 v8, s[48:51], s74 offen lds
    s_waitcnt lgkmcnt(4)
    v_mfma_f32_32x32x16_bf16 v[80:95], v[96:99], v[108:111], v[80:95]
    s_waitcnt vmcnt(8)
    ds_read_b64_tr_b16 v[96:97], v6 offset:0
    ds_read_b64_tr_b16 v[98:99], v6 offset:256
    ds_read_b128 v[104:107], v60 offset:5120
    ds_read_b128 v[108:111], v60 offset:37888
    s_waitcnt lgkmcnt(6)
    v_mfma_f32_16x16x32_bf16 v[204:207], v[100:103], v[200:203], v[204:207]
    s_waitcnt lgkmcnt(5)
    v_mfma_f32_32x32x16_bf16 v[64:79], v[100:103], v[112:115], v[64:79]
    s_add_u32 m0, s14, 9216
    s_add_u32 s74, s12, 0
    s_add_u32 s12, s12, s13
    buffer_load_dwordx4 v8, s[48:51], s74 offen lds
    s_waitcnt lgkmcnt(4)
    v_mfma_f32_32x32x16_bf16 v[80:95], v[100:103], v[116:119], v[80:95]
    s_waitcnt vmcnt(8)
    ds_read_b64_tr_b16 v[100:101], v6 offset:1024
    ds_read_b64_tr_b16 v[102:103], v6 offset:1280
    ds_read_b128 v[112:115], v61 offset:5120
    ds_read_b128 v[116:119], v61 offset:37888
    s_waitcnt lgkmcnt(6)
    v_mfma_f32_16x16x32_bf16 v[204:207], v[96:99], v[200:203], v[204:207]
    s_waitcnt lgkmcnt(5)
    v_mfma_f32_32x32x16_bf16 v[64:79], v[96:99], v[104:107], v[64:79]
    s_add_u32 m0, s14, 0
    s_add_u32 s74, s12, 0
    s_add_u32 s12, s12, s13
    buffer_load_dwordx4 v8, s[48:51], s74 offen lds
    s_waitcnt lgkmcnt(4)
    v_mfma_f32_32x32x16_bf16 v[80:95], v[96:99], v[108:111], v[80:95]
    s_waitcnt vmcnt(8)
    ds_read_b64_tr_b16 v[96:97], v6 offset:2048
    ds_read_b64_tr_b16 v[98:99], v6 offset:2304
    ds_read_b128 v[104:107], v62 offset:5120
    ds_read_b128 v[108:111], v62 offset:37888
    s_waitcnt lgkmcnt(6)
    v_mfma_f32_16x16x32_bf16 v[204:207], v[100:103], v[200:203], v[204:207]
    s_waitcnt lgkmcnt(5)
    v_mfma_f32_32x32x16_bf16 v[64:79], v[100:103], v[112:115], v[64:79]
    s_add_u32 m0, s14, 1024
    s_add_u32 s74, s12, 0
    s_add_u32 s12, s12, s13
    buffer_load_dwordx4 v8, s[48:51], s74 offen lds
    s_waitcnt lgkmcnt(4)
    v_mfma_f32_32x32x16_bf16 v[80:95], v[100:103], v[116:119], v[80:95]
    s_waitcnt vmcnt(8)
    ds_read_b64_tr_b16 v[100:101], v6 offset:3072
    ds_read_b64_tr_b16 v[102:103], v6 offset:3328
    ds_read_b128 v[112:115], v63 offset:5120
    ds_read_b128 v[116:119], v63 offset:37888
    s_waitcnt lgkmcnt(6)
    v_mfma_f32_16x16x32_bf16 v[204:207], v[96:99], v[200:203], v[204:207]
    s_waitcnt lgkmcnt(5)
    v_mfma_f32_32x32x16_bf16 v[64:79], v[96:99], v[104:107], v[64:79]
    s_waitcnt lgkmcnt(4)
    v_mfma_f32_32x32x16_bf16 v[80:95], v[96:99], v[108:111], v[80:95]
    s_waitcnt vmcnt(7)
    ds_read_b64_tr_b16 v[96:97], v6 offset:4096
    ds_read_b64_tr_b16 v[98:99], v6 offset:4352
    ds_read_b128 v[104:107], v60 offset:6144
    ds_read_b128 v[108:111], v60 offset:38912
    s_waitcnt lgkmcnt(6)
    v_mfma_f32_16x16x32_bf16 v[204:207], v[100:103], v[200:203], v[204:207]
    s_waitcnt lgkmcnt(5)
    v_mfma_f32_32x32x16_bf16 v[64:79], v[100:103], v[112:115], v[64:79]
    ds_read2_b32 v[58:59], v57 offset0:64 offset1:96
    ds_read2_b32 v[160:161], v57 offset0:128 offset1:160
    ds_read2_b32 v[174:175], v57 offset0:0 offset1:32
    s_lshl_b32 s7, s9, 12
    v_mov_b32 v168, 0xbdd2d3e8
    v_mov_b32 v170, 0xc0135761
    v_mov_b32 v172, 1.0
    s_waitcnt lgkmcnt(7)
    v_mfma_f32_32x32x16_bf16 v[80:95], v[100:103], v[116:119], v[80:95]
    s_waitcnt vmcnt(6)
    ds_read_b64_tr_b16 v[100:101], v6 offset:5120
    ds_read_b64_tr_b16 v[102:103], v6 offset:5376
    ds_read_b128 v[112:115], v61 offset:6144
    ds_read_b128 v[116:119], v61 offset:38912
    s_waitcnt lgkmcnt(9)
    v_mfma_f32_16x16x32_bf16 v[204:207], v[96:99], v[200:203], v[204:207]
    s_waitcnt lgkmcnt(8)
    v_mfma_f32_32x32x16_bf16 v[64:79], v[96:99], v[104:107], v[64:79]
    v_lshlrev_b32 v176, 16, v120
    v_and_b32 v177, 0xffff0000, v120
    v_lshlrev_b32 v178, 16, v121
    v_and_b32 v179, 0xffff0000, v121
    v_lshlrev_b32 v180, 16, v122
    v_and_b32 v181, 0xffff0000, v122
    v_lshlrev_b32 v182, 16, v123
    v_and_b32 v183, 0xffff0000, v123
    s_waitcnt lgkmcnt(7)
    v_mfma_f32_32x32x16_bf16 v[80:95], v[96:99], v[108:111], v[80:95]
    s_waitcnt vmcnt(5)
    ds_read_b64_tr_b16 v[96:97], v6 offset:6144
    ds_read_b64_tr_b16 v[98:99], v6 offset:6400
    ds_read_b128 v[104:107], v62 offset:6144
    ds_read_b128 v[108:111], v62 offset:38912
    s_waitcnt lgkmcnt(6)
    v_mfma_f32_16x16x32_bf16 v[204:207], v[100:103], v[200:203], v[204:207]
    s_waitcnt lgkmcnt(5)
    v_mfma_f32_32x32x16_bf16 v[64:79], v[100:103], v[112:115], v[64:79]
    v_lshlrev_b32 v184, 16, v124
    v_and_b32 v185, 0xffff0000, v124
    v_lshlrev_b32 v186, 16, v125
    v_and_b32 v187, 0xffff0000, v125
    v_lshlrev_b32 v188, 16, v126
    v_and_b32 v189, 0xffff0000, v126
    v_lshlrev_b32 v190, 16, v127
    v_and_b32 v191, 0xffff0000, v127
    s_waitcnt lgkmcnt(4)
    v_mfma_f32_32x32x16_bf16 v[80:95], v[100:103], v[116:119], v[80:95]
    s_waitcnt vmcnt(4)
    ds_read_b64_tr_b16 v[100:101], v6 offset:7168
    ds_read_b64_tr_b16 v[102:103], v6 offset:7424
    ds_read_b128 v[112:115], v63 offset:6144
    ds_read_b128 v[116:119], v63 offset:38912
    s_waitcnt lgkmcnt(6)
    v_mfma_f32_16x16x32_bf16 v[204:207], v[96:99], v[200:203], v[204:207]
    s_waitcnt lgkmcnt(5)
    v_mfma_f32_32x32x16_bf16 v[64:79], v[96:99], v[104:107], v[64:79]
    v_mov_b32 v162, v59
    v_mov_b32 v164, v161
    v_mul_f32 v174, 0x3eb8aa3b, v174
    v_mul_f32 v175, 0x3eb8aa3b, v175
    s_lshl_b32 s8, s42, 12
    s_add_u32 s8, s8, 147968
    v_add_u32 v56, s8, v5
    s_waitcnt lgkmcnt(4)
    v_mfma_f32_32x32x16_bf16 v[80:95], v[96:99], v[108:111], v[80:95]
    s_waitcnt vmcnt(3)
    ds_read_b64_tr_b16 v[96:97], v6 offset:8192
    ds_read_b64_tr_b16 v[98:99], v6 offset:8448
    ds_read_b128 v[104:107], v60 offset:7168
    ds_read_b128 v[108:111], v60 offset:39936
    s_waitcnt lgkmcnt(6)
    v_mfma_f32_16x16x32_bf16 v[204:207], v[100:103], v[200:203], v[204:207]
    s_waitcnt lgkmcnt(5)
    v_mfma_f32_32x32x16_bf16 v[64:79], v[100:103], v[112:115], v[64:79]
    s_cmp_ge_u32 s3, 2
    s_cbranch_scc1 L_nopre
    s_mov_b32 s85, 135168
    buffer_load_dword v132, v10, s[56:59], s85 offen sc1
L_nopre:
    s_waitcnt lgkmcnt(4)
    v_mfma_f32_32x32x16_bf16 v[80:95], v[100:103], v[116:119], v[80:95]
    s_waitcnt vmcnt(2)
    ds_read_b64_tr_b16 v[100:101], v6 offset:9216
    ds_read_b64_tr_b16 v[102:103], v6 offset:9472
    ds_read_b128 v[112:115], v61 offset:7168
    ds_read_b128 v[116:119], v61 offset:39936
    s_waitcnt lgkmcnt(6)
    v_mfma_f32_16x16x32_bf16 v[204:207], v[96:99], v[200:203], v[204:207]
    s_waitcnt lgkmcnt(5)
    v_mfma_f32_32x32x16_bf16 v[64:79], v[96:99], v[104:107], v[64:79]
    s_waitcnt lgkmcnt(4)
    v_mfma_f32_32x32x16_bf16 v[80:95], v[96:99], v[108:111], v[80:95]
    s_waitcnt vmcnt(1)
    ds_read_b64_tr_b16 v[96:97], v6 offset:0
    ds_read_b64_tr_b16 v[98:99], v6 offset:256
    ds_read_b128 v[104:107], v62 offset:7168
    ds_read_b128 v[108:111], v62 offset:39936
    s_waitcnt lgkmcnt(6)
    v_mfma_f32_16x16x32_bf16 v[204:207], v[100:103], v[200:203], v[204:207]
    s_waitcnt lgkmcnt(5)
    v_mfma_f32_32x32x16_bf16 v[64:79], v[100:103], v[112:115], v[64:79]
    s_waitcnt lgkmcnt(4)
    v_mfma_f32_32x32x16_bf16 v[80:95], v[100:103], v[116:119], v[80:95]
    s_waitcnt vmcnt(0)
    ds_read_b64_tr_b16 v[100:101], v6 offset:1024
    ds_read_b64_tr_b16 v[102:103], v6 offset:1280
    ds_read_b128 v[112:115], v63 offset:7168
    ds_read_b128 v[116:119], v63 offset:39936
    s_waitcnt lgkmcnt(6)
    v_mfma_f32_16x16x32_bf16 v[204:207], v[96:99], v[200:203], v[204:207]
    s_waitcnt lgkmcnt(5)
    v_mfma_f32_32x32x16_bf16 v[64:79], v[96:99], v[104:107], v[64:79]
    s_waitcnt lgkmcnt(4)
    v_mfma_f32_32x32x16_bf16 v[80:95], v[96:99], v[108:111], v[80:95]
    s_waitcnt lgkmcnt(2)
    v_mfma_f32_16x16x32_bf16 v[204:207], v[100:103], v[200:203], v[204:207]
    s_waitcnt lgkmcnt(1)
    v_mfma_f32_32x32x16_bf16 v[64:79], v[100:103], v[112:115], v[64:79]
    s_waitcnt lgkmcnt(0)
    v_mfma_f32_32x32x16_bf16 v[80:95], v[100:103], v[116:119], v[80:95]
    s_mov_b32 s73, 0
    s_cmp_ge_u32 s3, 2
    s_cbranch_scc1 L_noearly
    s_waitcnt vmcnt(0)
    v_cmp_eq_u32 vcc, s84, v132
    s_nop 1
    s_cmp_eq_u64 vcc, exec
    s_nop 3
    s_cbranch_scc0 L_noearly
    s_mov_b32 s73, 1
    s_and_b32 s10, s3, 1
    s_lshl_b32 s10, s10, 15
    s_lshr_b32 s12, s3, 1
    s_lshl_b32 s12, s12, 2
    s_add_u32 s12, s12, s75
    s_add_u32 s11, s12, 0
    s_and_b32 s11, s11, 31
    s_lshl_b32 s11, s11, 10
    s_add_u32 s11, s11, s10
    s_add_u32 m0, s14, 0
    s_add_u32 s13, s11, 65536
    buffer_load_dwordx4 v5, s[56:59], s11 offen sc1 lds
    s_add_u32 m0, s14, 1024
    s_nop 0
    buffer_load_dwordx4 v5, s[56:59], s13 offen sc1 lds
    s_add_u32 s11, s12, 1
    s_and_b32 s11, s11, 31
    s_lshl_b32 s11, s11, 10
    s_add_u32 s11, s11, s10
    s_add_u32 m0, s14, 2064
    s_add_u32 s13, s11, 65536
    buffer_load_dwordx4 v5, s[56:59], s11 offen sc1 lds
    s_add_u32 m0, s14, 3088
    s_nop 0
    buffer_load_dwordx4 v5, s[56:59], s13 offen sc1 lds
    s_add_u32 s11, s12, 2
    s_and_b32 s11, s11, 31
    s_lshl_b32 s11, s11, 10
    s_add_u32 s11, s11, s10
    s_add_u32 m0, s14, 4128
    s_add_u32 s13, s11, 65536
    buffer_load_dwordx4 v5, s[56:59], s11 offen sc1 lds
    s_add_u32 m0, s14, 5152
    s_nop 0
    buffer_load_dwordx4 v5, s[56:59], s13 offen sc1 lds
    s_add_u32 s11, s12, 3
    s_and_b32 s11, s11, 31
    s_lshl_b32 s11, s11, 10
    s_add_u32 s11, s11, s10
    s_add_u32 m0, s14, 6192
    s_add_u32 s13, s11, 65536
    buffer_load_dwordx4 v5, s[56:59], s11 offen sc1 lds
    s_add_u32 m0, s14, 7216
    s_nop 0
    buffer_load_dwordx4 v5, s[56:59], s13 offen sc1 lds
    v_mov_b32 v136, 0x3f803f80
    v_mov_b32 v137, 0x3f803f80
    v_mov_b32 v138, 0x3f803f80
    v_mov_b32 v139, 0x3f803f80
    v_and_b32 v140, 3, v0
    v_mul_u32_u24 v140, 2064, v140
    v_add_u32 v140, s14, v140
    ds_write_b128 v140, v[136:139] offset:2048
    s_nop 0
L_noearly:
    s_nop 0
    ds_write_b128 v54, v[204:207]
    ds_read_b128 v[144:147], v55 offset:0
    ds_read_b128 v[148:151], v55 offset:32
    ds_read_b128 v[152:155], v55 offset:64
    ds_read_b128 v[156:159], v55 offset:96
    s_cmp_lt_u32 s42, 2
    s_nop 1
    s_cbranch_scc0 L_mlp
    s_waitcnt lgkmcnt(3)
    v_fmac_f32 v64, v144, v160
    v_fmac_f32 v65, v145, v160
    v_fmac_f32 v66, v146, v160
    v_fmac_f32 v67, v147, v160
    s_waitcnt lgkmcnt(2)
    v_fmac_f32 v68, v148, v160
    v_fmac_f32 v69, v149, v160
    v_fmac_f32 v70, v150, v160
    v_fmac_f32 v71, v151, v160
    s_waitcnt lgkmcnt(1)
    v_fmac_f32 v72, v152, v160
    v_fmac_f32 v73, v153, v160
    v_fmac_f32 v74, v154, v160
    v_fmac_f32 v75, v155, v160
    s_waitcnt lgkmcnt(0)
    v_fmac_f32 v76, v156, v160
    v_fmac_f32 v77, v157, v160
    v_fmac_f32 v78, v158, v160
    v_fmac_f32 v79, v159, v160
    v_mul_f32 v64, v64, v174
    v_mul_f32 v65, v65, v174
    v_mul_f32 v66, v66, v174
    v_mul_f32 v67, v67, v174
    v_mul_f32 v68, v68, v174
    v_mul_f32 v69, v69, v174
    v_mul_f32 v70, v70, v174
    v_mul_f32 v71, v71, v174
    v_mul_f32 v72, v72, v174
    v_mul_f32 v73, v73, v174
    v_mul_f32 v74, v74, v174
    v_mul_f32 v75, v75, v174
    v_mul_f32 v76, v76, v174
    v_mul_f32 v77, v77, v174
    v_mul_f32 v78, v78, v174
    v_mul_f32 v79, v79, v174
    v_cvt_pk_bf16_f32 v104, v64, v65
    v_cvt_pk_bf16_f32 v105, v66, v67
    v_cvt_pk_bf16_f32 v106, v68, v69
    v_cvt_pk_bf16_f32 v107, v70, v71
    ds_write_b128 v56, v[104:107] offset:0
    v_cvt_pk_bf16_f32 v108, v72, v73
    v_cvt_pk_bf16_f32 v109, v74, v75
    v_cvt_pk_bf16_f32 v110, v76, v77
    v_cvt_pk_bf16_f32 v111, v78, v79
    ds_write_b128 v56, v[108:111] offset:1024
    v_fmac_f32 v80, v144, v161
    v_fmac_f32 v81, v145, v161
    v_fmac_f32 v82, v146, v161
    v_fmac_f32 v83, v147, v161
    v_fmac_f32 v84, v148, v161
    v_fmac_f32 v85, v149, v161
    v_fmac_f32 v86, v150, v161
    v_fmac_f32 v87, v151, v161
    v_fmac_f32 v88, v152, v161
    v_fmac_f32 v89, v153, v161
    v_fmac_f32 v90, v154, v161
    v_fmac_f32 v91, v155, v161
    v_fmac_f32 v92, v156, v161
    v_fmac_f32 v93, v157, v161
    v_fmac_f32 v94, v158, v161
    v_fmac_f32 v95, v159, v161
    v_mul_f32 v80, v80, v175
    v_mul_f32 v81, v81, v175
    v_mul_f32 v82, v82, v175
    v_mul_f32 v83, v83, v175
    v_mul_f32 v84, v84, v175
    v_mul_f32 v85, v85, v175
    v_mul_f32 v86, v86, v175
    v_mul_f32 v87, v87, v175
    v_mul_f32 v88, v88, v175
    v_mul_f32 v89, v89, v175
    v_mul_f32 v90, v90, v175
    v_mul_f32 v91, v91, v175
    v_mul_f32 v92, v92, v175
    v_mul_f32 v93, v93, v175
    v_mul_f32 v94, v94, v175
    v_mul_f32 v95, v95, v175
    v_cvt_pk_bf16_f32 v112, v80, v81
    v_cvt_pk_bf16_f32 v113, v82, v83
    v_cvt_pk_bf16_f32 v114, v84, v85
    v_cvt_pk_bf16_f32 v115, v86, v87
    ds_write_b128 v56, v[112:115] offset:2048
    v_cvt_pk_bf16_f32 v116, v88, v89
    v_cvt_pk_bf16_f32 v117, v90, v91
    v_cvt_pk_bf16_f32 v118, v92, v93
    v_cvt_pk_bf16_f32 v119, v94, v95
    ds_write_b128 v56, v[116:119] offset:3072
    s_nop 0
    s_branch L_done
L_mlp:
    s_cmp_ge_u32 s3, 4
    s_cbranch_scc1 L_young
    s_waitcnt lgkmcnt(3)
    v_fmac_f32 v64, v144, v160
    v_fmac_f32 v65, v145, v160
    v_fmac_f32 v66, v146, v160
    v_fmac_f32 v67, v147, v160
    s_waitcnt lgkmcnt(2)
    v_fmac_f32 v68, v148, v160
    v_fmac_f32 v69, v149, v160
    v_fmac_f32 v70, v150, v160
    v_fmac_f32 v71, v151, v160
    v_fma_f32 v64, v64, v58, v176
    v_fma_f32 v65, v65, v58, v177
    v_fma_f32 v66, v66, v58, v178
    v_fma_f32 v67, v67, v58, v179
    v_fma_f32 v68, v68, v58, v180
    v_fma_f32 v69, v69, v58, v181
    v_fma_f32 v70, v70, v58, v182
    v_fma_f32 v71, v71, v58, v183
    v_mul_f32 v192, v64, v64
    v_mul_f32 v193, v65, v65
    v_mul_f32 v194, v66, v66
    v_mul_f32 v195, v67, v67
    v_mul_f32 v196, v68, v68
    v_mul_f32 v197, v69, v69
    v_mul_f32 v198, v70, v70
    v_mul_f32 v199, v71, v71
    v_fmaak_f32 v192, v192, v168, 0xc0135761
    v_fmaak_f32 v193, v193, v168, 0xc0135761
    v_fmaak_f32 v194, v194, v168, 0xc0135761
    v_fmaak_f32 v195, v195, v168, 0xc0135761
    v_fmaak_f32 v196, v196, v168, 0xc0135761
    v_fmaak_f32 v197, v197, v168, 0xc0135761
    v_fmaak_f32 v198, v198, v168, 0xc0135761
    v_fmaak_f32 v199, v199, v168, 0xc0135761
    v_mul_f32 v192, v192, v64
    v_mul_f32 v193, v193, v65
    v_mul_f32 v194, v194, v66
    v_mul_f32 v195, v195, v67
    v_mul_f32 v196, v196, v68
    v_mul_f32 v197, v197, v69
    v_mul_f32 v198, v198, v70
    v_mul_f32 v199, v199, v71
    v_exp_f32 v192, v192
    v_exp_f32 v193, v193
    v_exp_f32 v194, v194
    v_exp_f32 v195, v195
    v_exp_f32 v196, v196
    v_exp_f32 v197, v197
    v_exp_f32 v198, v198
    v_exp_f32 v199, v199
    v_add_f32 v192, 1.0, v192
    v_add_f32 v193, 1.0, v193
    v_add_f32 v194, 1.0, v194
    v_add_f32 v195, 1.0, v195
    v_add_f32 v196, 1.0, v196
    v_add_f32 v197, 1.0, v197
    v_add_f32 v198, 1.0, v198
    v_add_f32 v199, 1.0, v199
    v_rcp_f32 v192, v192
    v_rcp_f32 v193, v193
    v_rcp_f32 v194, v194
    v_rcp_f32 v195, v195
    v_rcp_f32 v196, v196
    v_rcp_f32 v197, v197
    v_rcp_f32 v198, v198
    v_rcp_f32 v199, v199
    v_mul_f32 v64, v64, v192
    v_mul_f32 v65, v65, v193
    v_mul_f32 v66, v66, v194
    v_mul_f32 v67, v67, v195
    v_mul_f32 v68, v68, v196
    v_mul_f32 v69, v69, v197
    v_mul_f32 v70, v70, v198
    v_mul_f32 v71, v71, v199
    v_cvt_pk_bf16_f32 v104, v64, v65
    v_cvt_pk_bf16_f32 v105, v66, v67
    v_cvt_pk_bf16_f32 v106, v68, v69
    v_cvt_pk_bf16_f32 v107, v70, v71
    buffer_store_dwordx4 v[104:107], v5, s[68:71], s7 offen offset:0 sc1
    s_waitcnt lgkmcnt(1)
    v_fmac_f32 v72, v152, v160
    v_fmac_f32 v73, v153, v160
    v_fmac_f32 v74, v154, v160
    v_fmac_f32 v75, v155, v160
    s_waitcnt lgkmcnt(0)
    v_fmac_f32 v76, v156, v160
    v_fmac_f32 v77, v157, v160
    v_fmac_f32 v78, v158, v160
    v_fmac_f32 v79, v159, v160
    v_fma_f32 v72, v72, v58, v184
    v_fma_f32 v73, v73, v58, v185
    v_fma_f32 v74, v74, v58, v186
    v_fma_f32 v75, v75, v58, v187
    v_fma_f32 v76, v76, v58, v188
    v_fma_f32 v77, v77, v58, v189
    v_fma_f32 v78, v78, v58, v190
    v_fma_f32 v79, v79, v58, v191
    v_mul_f32 v192, v72, v72
    v_mul_f32 v193, v73, v73
    v_mul_f32 v194, v74, v74
    v_mul_f32 v195, v75, v75
    v_mul_f32 v196, v76, v76
    v_mul_f32 v197, v77, v77
    v_mul_f32 v198, v78, v78
    v_mul_f32 v199, v79, v79
    v_fmaak_f32 v192, v192, v168, 0xc0135761
    v_fmaak_f32 v193, v193, v168, 0xc0135761
    v_fmaak_f32 v194, v194, v168, 0xc0135761
    v_fmaak_f32 v195, v195, v168, 0xc0135761
    v_fmaak_f32 v196, v196, v168, 0xc0135761
    v_fmaak_f32 v197, v197, v168, 0xc0135761
    v_fmaak_f32 v198, v198, v168, 0xc0135761
    v_fmaak_f32 v199, v199, v168, 0xc0135761
    v_mul_f32 v192, v192, v72
    v_mul_f32 v193, v193, v73
    v_mul_f32 v194, v194, v74
    v_mul_f32 v195, v195, v75
    v_mul_f32 v196, v196, v76
    v_mul_f32 v197, v197, v77
    v_mul_f32 v198, v198, v78
    v_mul_f32 v199, v199, v79
    v_exp_f32 v192, v192
    v_exp_f32 v193, v193
    v_exp_f32 v194, v194
    v_exp_f32 v195, v195
    v_exp_f32 v196, v196
    v_exp_f32 v197, v197
    v_exp_f32 v198, v198
    v_exp_f32 v199, v199
    v_add_f32 v192, 1.0, v192
    v_add_f32 v193, 1.0, v193
    v_add_f32 v194, 1.0, v194
    v_add_f32 v195, 1.0, v195
    v_add_f32 v196, 1.0, v196
    v_add_f32 v197, 1.0, v197
    v_add_f32 v198, 1.0, v198
    v_add_f32 v199, 1.0, v199
    v_rcp_f32 v192, v192
    v_rcp_f32 v193, v193
    v_rcp_f32 v194, v194
    v_rcp_f32 v195, v195
    v_rcp_f32 v196, v196
    v_rcp_f32 v197, v197
    v_rcp_f32 v198, v198
    v_rcp_f32 v199, v199
    v_mul_f32 v72, v72, v192
    v_mul_f32 v73, v73, v193
    v_mul_f32 v74, v74, v194
    v_mul_f32 v75, v75, v195
    v_mul_f32 v76, v76, v196
    v_mul_f32 v77, v77, v197
    v_mul_f32 v78, v78, v198
    v_mul_f32 v79, v79, v199
    v_cvt_pk_bf16_f32 v108, v72, v73
    v_cvt_pk_bf16_f32 v109, v74, v75
    v_cvt_pk_bf16_f32 v110, v76, v77
    v_cvt_pk_bf16_f32 v111, v78, v79
    buffer_store_dwordx4 v[108:111], v5, s[68:71], s7 offen offset:2048 sc1
    v_fmac_f32 v80, v144, v161
    v_fmac_f32 v81, v145, v161
    v_fmac_f32 v82, v146, v161
    v_fmac_f32 v83, v147, v161
    v_fmac_f32 v84, v148, v161
    v_fmac_f32 v85, v149, v161
    v_fmac_f32 v86, v150, v161
    v_fmac_f32 v87, v151, v161
    v_fma_f32 v80, v80, v59, v176
    v_fma_f32 v81, v81, v59, v177
    v_fma_f32 v82, v82, v59, v178
    v_fma_f32 v83, v83, v59, v179
    v_fma_f32 v84, v84, v59, v180
    v_fma_f32 v85, v85, v59, v181
    v_fma_f32 v86, v86, v59, v182
    v_fma_f32 v87, v87, v59, v183
    v_mul_f32 v192, v80, v80
    v_mul_f32 v193, v81, v81
    v_mul_f32 v194, v82, v82
    v_mul_f32 v195, v83, v83
    v_mul_f32 v196, v84, v84
    v_mul_f32 v197, v85, v85
    v_mul_f32 v198, v86, v86
    v_mul_f32 v199, v87, v87
    v_fmaak_f32 v192, v192, v168, 0xc0135761
    v_fmaak_f32 v193, v193, v168, 0xc0135761
    v_fmaak_f32 v194, v194, v168, 0xc0135761
    v_fmaak_f32 v195, v195, v168, 0xc0135761
    v_fmaak_f32 v196, v196, v168, 0xc0135761
    v_fmaak_f32 v197, v197, v168, 0xc0135761
    v_fmaak_f32 v198, v198, v168, 0xc0135761
    v_fmaak_f32 v199, v199, v168, 0xc0135761
    v_mul_f32 v192, v192, v80
    v_mul_f32 v193, v193, v81
    v_mul_f32 v194, v194, v82
    v_mul_f32 v195, v195, v83
    v_mul_f32 v196, v196, v84
    v_mul_f32 v197, v197, v85
    v_mul_f32 v198, v198, v86
    v_mul_f32 v199, v199, v87
    v_exp_f32 v192, v192
    v_exp_f32 v193, v193
    v_exp_f32 v194, v194
    v_exp_f32 v195, v195
    v_exp_f32 v196, v196
    v_exp_f32 v197, v197
    v_exp_f32 v198, v198
    v_exp_f32 v199, v199
    v_add_f32 v192, 1.0, v192
    v_add_f32 v193, 1.0, v193
    v_add_f32 v194, 1.0, v194
    v_add_f32 v195, 1.0, v195
    v_add_f32 v196, 1.0, v196
    v_add_f32 v197, 1.0, v197
    v_add_f32 v198, 1.0, v198
    v_add_f32 v199, 1.0, v199
    v_rcp_f32 v192, v192
    v_rcp_f32 v193, v193
    v_rcp_f32 v194, v194
    v_rcp_f32 v195, v195
    v_rcp_f32 v196, v196
    v_rcp_f32 v197, v197
    v_rcp_f32 v198, v198
    v_rcp_f32 v199, v199
    v_mul_f32 v80, v80, v192
    v_mul_f32 v81, v81, v193
    v_mul_f32 v82, v82, v194
    v_mul_f32 v83, v83, v195
    v_mul_f32 v84, v84, v196
    v_mul_f32 v85, v85, v197
    v_mul_f32 v86, v86, v198
    v_mul_f32 v87, v87, v199
    v_cvt_pk_bf16_f32 v112, v80, v81
    v_cvt_pk_bf16_f32 v113, v82, v83
    v_cvt_pk_bf16_f32 v114, v84, v85
    v_cvt_pk_bf16_f32 v115, v86, v87
    buffer_store_dwordx4 v[112:115], v5, s[68:71], s7 offen offset:1024 sc1
    v_fmac_f32 v88, v152, v161
    v_fmac_f32 v89, v153, v161
    v_fmac_f32 v90, v154, v161
    v_fmac_f32 v91, v155, v161
    v_fmac_f32 v92, v156, v161
    v_fmac_f32 v93, v157, v161
    v_fmac_f32 v94, v158, v161
    v_fmac_f32 v95, v159, v161
    v_fma_f32 v88, v88, v59, v184
    v_fma_f32 v89, v89, v59, v185
    v_fma_f32 v90, v90, v59, v186
    v_fma_f32 v91, v91, v59, v187
    v_fma_f32 v92, v92, v59, v188
    v_fma_f32 v93, v93, v59, v189
    v_fma_f32 v94, v94, v59, v190
    v_fma_f32 v95, v95, v59, v191
    v_mul_f32 v192, v88, v88
    v_mul_f32 v193, v89, v89
    v_mul_f32 v194, v90, v90
    v_mul_f32 v195, v91, v91
    v_mul_f32 v196, v92, v92
    v_mul_f32 v197, v93, v93
    v_mul_f32 v198, v94, v94
    v_mul_f32 v199, v95, v95
    v_fmaak_f32 v192, v192, v168, 0xc0135761
    v_fmaak_f32 v193, v193, v168, 0xc0135761
    v_fmaak_f32 v194, v194, v168, 0xc0135761
    v_fmaak_f32 v195, v195, v168, 0xc0135761
    v_fmaak_f32 v196, v196, v168, 0xc0135761
    v_fmaak_f32 v197, v197, v168, 0xc0135761
    v_fmaak_f32 v198, v198, v168, 0xc0135761
    v_fmaak_f32 v199, v199, v168, 0xc0135761
    v_mul_f32 v192, v192, v88
    v_mul_f32 v193, v193, v89
    v_mul_f32 v194, v194, v90
    v_mul_f32 v195, v195, v91
    v_mul_f32 v196, v196, v92
    v_mul_f32 v197, v197, v93
    v_mul_f32 v198, v198, v94
    v_mul_f32 v199, v199, v95
    v_exp_f32 v192, v192
    v_exp_f32 v193, v193
    v_exp_f32 v194, v194
    v_exp_f32 v195, v195
    v_exp_f32 v196, v196
    v_exp_f32 v197, v197
    v_exp_f32 v198, v198
    v_exp_f32 v199, v199
    v_add_f32 v192, 1.0, v192
    v_add_f32 v193, 1.0, v193
    v_add_f32 v194, 1.0, v194
    v_add_f32 v195, 1.0, v195
    v_add_f32 v196, 1.0, v196
    v_add_f32 v197, 1.0, v197
    v_add_f32 v198, 1.0, v198
    v_add_f32 v199, 1.0, v199
    v_rcp_f32 v192, v192
    v_rcp_f32 v193, v193
    v_rcp_f32 v194, v194
    v_rcp_f32 v195, v195
    v_rcp_f32 v196, v196
    v_rcp_f32 v197, v197
    v_rcp_f32 v198, v198
    v_rcp_f32 v199, v199
    v_mul_f32 v88, v88, v192
    v_mul_f32 v89, v89, v193
    v_mul_f32 v90, v90, v194
    v_mul_f32 v91, v91, v195
    v_mul_f32 v92, v92, v196
    v_mul_f32 v93, v93, v197
    v_mul_f32 v94, v94, v198
    v_mul_f32 v95, v95, v199
    v_cvt_pk_bf16_f32 v116, v88, v89
    v_cvt_pk_bf16_f32 v117, v90, v91
    v_cvt_pk_bf16_f32 v118, v92, v93
    v_cvt_pk_bf16_f32 v119, v94, v95
    buffer_store_dwordx4 v[116:119], v5, s[68:71], s7 offen offset:3072 sc1
    s_nop 1
    s_branch L_late
L_young:
    s_waitcnt lgkmcnt(3)
    v_pk_fma_f32 v[64:65], v[144:145], v[160:161], v[64:65] op_sel_hi:[1,0,1]
    v_pk_fma_f32 v[66:67], v[146:147], v[160:161], v[66:67] op_sel_hi:[1,0,1]
    s_waitcnt lgkmcnt(2)
    v_pk_fma_f32 v[68:69], v[148:149], v[160:161], v[68:69] op_sel_hi:[1,0,1]
    v_pk_fma_f32 v[70:71], v[150:151], v[160:161], v[70:71] op_sel_hi:[1,0,1]
    v_pk_fma_f32 v[64:65], v[64:65], v[58:59], v[176:177] op_sel_hi:[1,0,1]
    v_pk_fma_f32 v[66:67], v[66:67], v[58:59], v[178:179] op_sel_hi:[1,0,1]
    v_pk_fma_f32 v[68:69], v[68:69], v[58:59], v[180:181] op_sel_hi:[1,0,1]
    v_pk_fma_f32 v[70:71], v[70:71], v[58:59], v[182:183] op_sel_hi:[1,0,1]
    v_pk_mul_f32 v[192:193], v[64:65], v[64:65]
    v_pk_mul_f32 v[194:195], v[66:67], v[66:67]
    v_pk_mul_f32 v[196:197], v[68:69], v[68:69]
    v_pk_mul_f32 v[198:199], v[70:71], v[70:71]
    v_pk_fma_f32 v[192:193], v[192:193], v[168:169], v[170:171] op_sel_hi:[1,0,0]
    v_pk_fma_f32 v[194:195], v[194:195], v[168:169], v[170:171] op_sel_hi:[1,0,0]
    v_pk_fma_f32 v[196:197], v[196:197], v[168:169], v[170:171] op_sel_hi:[1,0,0]
    v_pk_fma_f32 v[198:199], v[198:199], v[168:169], v[170:171] op_sel_hi:[1,0,0]
    v_pk_mul_f32 v[192:193], v[192:193], v[64:65]
    v_pk_mul_f32 v[194:195], v[194:195], v[66:67]
    v_pk_mul_f32 v[196:197], v[196:197], v[68:69]
    v_pk_mul_f32 v[198:199], v[198:199], v[70:71]
    v_exp_f32 v192, v192
    v_exp_f32 v193, v193
    v_exp_f32 v194, v194
    v_exp_f32 v195, v195
    v_exp_f32 v196, v196
    v_exp_f32 v197, v197
    v_exp_f32 v198, v198
    v_exp_f32 v199, v199
    v_pk_add_f32 v[192:193], v[192:193], v[172:173] op_sel_hi:[1,0]
    v_pk_add_f32 v[194:195], v[194:195], v[172:173] op_sel_hi:[1,0]
    v_pk_add_f32 v[196:197], v[196:197], v[172:173] op_sel_hi:[1,0]
    v_pk_add_f32 v[198:199], v[198:199], v[172:173] op_sel_hi:[1,0]
    v_rcp_f32 v192, v192
    v_rcp_f32 v193, v193
    v_rcp_f32 v194, v194
    v_rcp_f32 v195, v195
    v_rcp_f32 v196, v196
    v_rcp_f32 v197, v197
    v_rcp_f32 v198, v198
    v_rcp_f32 v199, v199
    v_pk_mul_f32 v[64:65], v[64:65], v[192:193]
    v_pk_mul_f32 v[66:67], v[66:67], v[194:195]
    v_pk_mul_f32 v[68:69], v[68:69], v[196:197]
    v_pk_mul_f32 v[70:71], v[70:71], v[198:199]
    v_cvt_pk_bf16_f32 v104, v64, v65
    v_cvt_pk_bf16_f32 v105, v66, v67
    v_cvt_pk_bf16_f32 v106, v68, v69
    v_cvt_pk_bf16_f32 v107, v70, v71
    buffer_store_dwordx4 v[104:107], v5, s[68:71], s7 offen offset:0 sc1
    s_waitcnt lgkmcnt(1)
    v_pk_fma_f32 v[72:73], v[152:153], v[160:161], v[72:73] op_sel_hi:[1,0,1]
    v_pk_fma_f32 v[74:75], v[154:155], v[160:161], v[74:75] op_sel_hi:[1,0,1]
    s_waitcnt lgkmcnt(0)
    v_pk_fma_f32 v[76:77], v[156:157], v[160:161], v[76:77] op_sel_hi:[1,0,1]
    v_pk_fma_f32 v[78:79], v[158:159], v[160:161], v[78:79] op_sel_hi:[1,0,1]
    v_pk_fma_f32 v[72:73], v[72:73], v[58:59], v[184:185] op_sel_hi:[1,0,1]
    v_pk_fma_f32 v[74:75], v[74:75], v[58:59], v[186:187] op_sel_hi:[1,0,1]
    v_pk_fma_f32 v[76:77], v[76:77], v[58:59], v[188:189] op_sel_hi:[1,0,1]
    v_pk_fma_f32 v[78:79], v[78:79], v[58:59], v[190:191] op_sel_hi:[1,0,1]
    v_pk_mul_f32 v[192:193], v[72:73], v[72:73]
    v_pk_mul_f32 v[194:195], v[74:75], v[74:75]
    v_pk_mul_f32 v[196:197], v[76:77], v[76:77]
    v_pk_mul_f32 v[198:199], v[78:79], v[78:79]
    v_pk_fma_f32 v[192:193], v[192:193], v[168:169], v[170:171] op_sel_hi:[1,0,0]
    v_pk_fma_f32 v[194:195], v[194:195], v[168:169], v[170:171] op_sel_hi:[1,0,0]
    v_pk_fma_f32 v[196:197], v[196:197], v[168:169], v[170:171] op_sel_hi:[1,0,0]
    v_pk_fma_f32 v[198:199], v[198:199], v[168:169], v[170:171] op_sel_hi:[1,0,0]
    v_pk_mul_f32 v[192:193], v[192:193], v[72:73]
    v_pk_mul_f32 v[194:195], v[194:195], v[74:75]
    v_pk_mul_f32 v[196:197], v[196:197], v[76:77]
    v_pk_mul_f32 v[198:199], v[198:199], v[78:79]
    v_exp_f32 v192, v192
    v_exp_f32 v193, v193
    v_exp_f32 v194, v194
    v_exp_f32 v195, v195
    v_exp_f32 v196, v196
    v_exp_f32 v197, v197
    v_exp_f32 v198, v198
    v_exp_f32 v199, v199
    v_pk_add_f32 v[192:193], v[192:193], v[172:173] op_sel_hi:[1,0]
    v_pk_add_f32 v[194:195], v[194:195], v[172:173] op_sel_hi:[1,0]
    v_pk_add_f32 v[196:197], v[196:197], v[172:173] op_sel_hi:[1,0]
    v_pk_add_f32 v[198:199], v[198:199], v[172:173] op_sel_hi:[1,0]
    v_rcp_f32 v192, v192
    v_rcp_f32 v193, v193
    v_rcp_f32 v194, v194
    v_rcp_f32 v195, v195
    v_rcp_f32 v196, v196
    v_rcp_f32 v197, v197
    v_rcp_f32 v198, v198
    v_rcp_f32 v199, v199
    v_pk_mul_f32 v[72:73], v[72:73], v[192:193]
    v_pk_mul_f32 v[74:75], v[74:75], v[194:195]
    v_pk_mul_f32 v[76:77], v[76:77], v[196:197]
    v_pk_mul_f32 v[78:79], v[78:79], v[198:199]
    v_cvt_pk_bf16_f32 v108, v72, v73
    v_cvt_pk_bf16_f32 v109, v74, v75
    v_cvt_pk_bf16_f32 v110, v76, v77
    v_cvt_pk_bf16_f32 v111, v78, v79
    buffer_store_dwordx4 v[108:111], v5, s[68:71], s7 offen offset:2048 sc1
    v_pk_fma_f32 v[80:81], v[144:145], v[164:165], v[80:81] op_sel_hi:[1,0,1]
    v_pk_fma_f32 v[82:83], v[146:147], v[164:165], v[82:83] op_sel_hi:[1,0,1]
    v_pk_fma_f32 v[84:85], v[148:149], v[164:165], v[84:85] op_sel_hi:[1,0,1]
    v_pk_fma_f32 v[86:87], v[150:151], v[164:165], v[86:87] op_sel_hi:[1,0,1]
    v_pk_fma_f32 v[80:81], v[80:81], v[162:163], v[176:177] op_sel_hi:[1,0,1]
    v_pk_fma_f32 v[82:83], v[82:83], v[162:163], v[178:179] op_sel_hi:[1,0,1]
    v_pk_fma_f32 v[84:85], v[84:85], v[162:163], v[180:181] op_sel_hi:[1,0,1]
    v_pk_fma_f32 v[86:87], v[86:87], v[162:163], v[182:183] op_sel_hi:[1,0,1]
    v_pk_mul_f32 v[192:193], v[80:81], v[80:81]
    v_pk_mul_f32 v[194:195], v[82:83], v[82:83]
    v_pk_mul_f32 v[196:197], v[84:85], v[84:85]
    v_pk_mul_f32 v[198:199], v[86:87], v[86:87]
    v_pk_fma_f32 v[192:193], v[192:193], v[168:169], v[170:171] op_sel_hi:[1,0,0]
    v_pk_fma_f32 v[194:195], v[194:195], v[168:169], v[170:171] op_sel_hi:[1,0,0]
    v_pk_fma_f32 v[196:197], v[196:197], v[168:169], v[170:171] op_sel_hi:[1,0,0]
    v_pk_fma_f32 v[198:199], v[198:199], v[168:169], v[170:171] op_sel_hi:[1,0,0]
    v_pk_mul_f32 v[192:193], v[192:193], v[80:81]
    v_pk_mul_f32 v[194:195], v[194:195], v[82:83]
    v_pk_mul_f32 v[196:197], v[196:197], v[84:85]
    v_pk_mul_f32 v[198:199], v[198:199], v[86:87]
    v_exp_f32 v192, v192
    v_exp_f32 v193, v193
    v_exp_f32 v194, v194
    v_exp_f32 v195, v195
    v_exp_f32 v196, v196
    v_exp_f32 v197, v197
    v_exp_f32 v198, v198
    v_exp_f32 v199, v199
    v_pk_add_f32 v[192:193], v[192:193], v[172:173] op_sel_hi:[1,0]
    v_pk_add_f32 v[194:195], v[194:195], v[172:173] op_sel_hi:[1,0]
    v_pk_add_f32 v[196:197], v[196:197], v[172:173] op_sel_hi:[1,0]
    v_pk_add_f32 v[198:199], v[198:199], v[172:173] op_sel_hi:[1,0]
    v_rcp_f32 v192, v192
    v_rcp_f32 v193, v193
    v_rcp_f32 v194, v194
    v_rcp_f32 v195, v195
    v_rcp_f32 v196, v196
    v_rcp_f32 v197, v197
    v_rcp_f32 v198, v198
    v_rcp_f32 v199, v199
    v_pk_mul_f32 v[80:81], v[80:81], v[192:193]
    v_pk_mul_f32 v[82:83], v[82:83], v[194:195]
    v_pk_mul_f32 v[84:85], v[84:85], v[196:197]
    v_pk_mul_f32 v[86:87], v[86:87], v[198:199]
    v_cvt_pk_bf16_f32 v112, v80, v81
    v_cvt_pk_bf16_f32 v113, v82, v83
    v_cvt_pk_bf16_f32 v114, v84, v85
    v_cvt_pk_bf16_f32 v115, v86, v87
    buffer_store_dwordx4 v[112:115], v5, s[68:71], s7 offen offset:1024 sc1
    v_pk_fma_f32 v[88:89], v[152:153], v[164:165], v[88:89] op_sel_hi:[1,0,1]
    v_pk_fma_f32 v[90:91], v[154:155], v[164:165], v[90:91] op_sel_hi:[1,0,1]
    v_pk_fma_f32 v[92:93], v[156:157], v[164:165], v[92:93] op_sel_hi:[1,0,1]
    v_pk_fma_f32 v[94:95], v[158:159], v[164:165], v[94:95] op_sel_hi:[1,0,1]
    v_pk_fma_f32 v[88:89], v[88:89], v[162:163], v[184:185] op_sel_hi:[1,0,1]
    v_pk_fma_f32 v[90:91], v[90:91], v[162:163], v[186:187] op_sel_hi:[1,0,1]
    v_pk_fma_f32 v[92:93], v[92:93], v[162:163], v[188:189] op_sel_hi:[1,0,1]
    v_pk_fma_f32 v[94:95], v[94:95], v[162:163], v[190:191] op_sel_hi:[1,0,1]
    v_pk_mul_f32 v[192:193], v[88:89], v[88:89]
    v_pk_mul_f32 v[194:195], v[90:91], v[90:91]
    v_pk_mul_f32 v[196:197], v[92:93], v[92:93]
    v_pk_mul_f32 v[198:199], v[94:95], v[94:95]
    v_pk_fma_f32 v[192:193], v[192:193], v[168:169], v[170:171] op_sel_hi:[1,0,0]
    v_pk_fma_f32 v[194:195], v[194:195], v[168:169], v[170:171] op_sel_hi:[1,0,0]
    v_pk_fma_f32 v[196:197], v[196:197], v[168:169], v[170:171] op_sel_hi:[1,0,0]
    v_pk_fma_f32 v[198:199], v[198:199], v[168:169], v[170:171] op_sel_hi:[1,0,0]
    v_pk_mul_f32 v[192:193], v[192:193], v[88:89]
    v_pk_mul_f32 v[194:195], v[194:195], v[90:91]
    v_pk_mul_f32 v[196:197], v[196:197], v[92:93]
    v_pk_mul_f32 v[198:199], v[198:199], v[94:95]
    v_exp_f32 v192, v192
    v_exp_f32 v193, v193
    v_exp_f32 v194, v194
    v_exp_f32 v195, v195
    v_exp_f32 v196, v196
    v_exp_f32 v197, v197
    v_exp_f32 v198, v198
    v_exp_f32 v199, v199
    v_pk_add_f32 v[192:193], v[192:193], v[172:173] op_sel_hi:[1,0]
    v_pk_add_f32 v[194:195], v[194:195], v[172:173] op_sel_hi:[1,0]
    v_pk_add_f32 v[196:197], v[196:197], v[172:173] op_sel_hi:[1,0]
    v_pk_add_f32 v[198:199], v[198:199], v[172:173] op_sel_hi:[1,0]
    v_rcp_f32 v192, v192
    v_rcp_f32 v193, v193
    v_rcp_f32 v194, v194
    v_rcp_f32 v195, v195
    v_rcp_f32 v196, v196
    v_rcp_f32 v197, v197
    v_rcp_f32 v198, v198
    v_rcp_f32 v199, v199
    v_pk_mul_f32 v[88:89], v[88:89], v[192:193]
    v_pk_mul_f32 v[90:91], v[90:91], v[194:195]
    v_pk_mul_f32 v[92:93], v[92:93], v[196:197]
    v_pk_mul_f32 v[94:95], v[94:95], v[198:199]
    v_cvt_pk_bf16_f32 v116, v88, v89
    v_cvt_pk_bf16_f32 v117, v90, v91
    v_cvt_pk_bf16_f32 v118, v92, v93
    v_cvt_pk_bf16_f32 v119, v94, v95
    buffer_store_dwordx4 v[116:119], v5, s[68:71], s7 offen offset:3072 sc1
    s_nop 1
    s_branch L_late
L_spare:
    s_cmp_eq_u32 s43, 2
    s_cbranch_scc1 L_idle
    v_and_b32 v128, 15, v0
    v_lshrrev_b32 v129, 4, v0
    s_and_b32 s8, s3, 1
    s_lshl_b32 s7, s8, 15
    v_lshrrev_b32 v130, 1, v128
    v_xor_b32 v130, v130, v129
    v_lshrrev_b32 v131, 3, v128
    v_lshlrev_b32 v131, 13, v131
    v_lshl_add_u32 v131, v3, 7, v131
    v_add_u32 v131, s7, v131
    v_lshl_add_u32 v60, v130, 4, v131
    v_xor_b32 v61, 64, v60
    s_and_b32 s7, s3, 6
    s_mul_i32 s7, s7, 10240
    s_add_u32 s7, s7, 66048
    v_lshlrev_b32 v6, 3, v128
    v_lshl_add_u32 v6, v129, 8, v6
    v_add_u32 v6, s7, v6
    v_mov_b32 v200, 0x3f803f80
    v_mov_b32 v201, 0x3f803f80
    v_mov_b32 v202, 0x3f803f80
    v_mov_b32 v203, 0x3f803f80
    s_lshl_b32 s10, s4, 1
    s_add_u32 s10, s10, s8
    s_lshl_b32 s10, s10, 10
    s_lshl_b32 s7, s8, 7
    s_add_u32 s7, s7, 156160
    s_cmp_lt_u32 s42, 6
    s_cbranch_scc0 L_doV
    ds_read_b64_tr_b16 v[144:145], v6 offset:0
    ds_read_b64_tr_b16 v[146:147], v6 offset:128
    ds_read_b128 v[148:151], v60 offset:0
    ds_read_b128 v[152:155], v60 offset:16384
    ds_read_b64_tr_b16 v[156:157], v6 offset:1024
    ds_read_b64_tr_b16 v[158:159], v6 offset:1152
    ds_read_b128 v[160:163], v61 offset:0
    ds_read_b128 v[164:167], v61 offset:16384
    ds_read_b64_tr_b16 v[168:169], v6 offset:2048
    ds_read_b64_tr_b16 v[170:171], v6 offset:2176
    ds_read_b128 v[172:175], v60 offset:1024
    ds_read_b128 v[176:179], v60 offset:17408
    ds_read_b64_tr_b16 v[180:181], v6 offset:3072
    ds_read_b64_tr_b16 v[182:183], v6 offset:3200
    ds_read_b128 v[184:187], v61 offset:1024
    ds_read_b128 v[188:191], v61 offset:17408
    s_waitcnt lgkmcnt(14)
    v_mfma_f32_16x16x32_bf16 v[72:75], v[144:147], v[200:203], 0
    s_waitcnt lgkmcnt(13)
    v_mfma_f32_16x16x32_bf16 v[64:67], v[144:147], v[148:151], 0
    s_waitcnt lgkmcnt(12)
    v_mfma_f32_16x16x32_bf16 v[68:71], v[144:147], v[152:155], 0
    ds_read_b64_tr_b16 v[144:145], v6 offset:4096
    ds_read_b64_tr_b16 v[146:147], v6 offset:4224
    ds_read_b128 v[148:151], v60 offset:2048
    ds_read_b128 v[152:155], v60 offset:18432
    s_waitcnt lgkmcnt(14)
    v_mfma_f32_16x16x32_bf16 v[72:75], v[156:159], v[200:203], v[72:75]
    s_waitcnt lgkmcnt(13)
    v_mfma_f32_16x16x32_bf16 v[64:67], v[156:159], v[160:163], v[64:67]
    s_waitcnt lgkmcnt(12)
    v_mfma_f32_16x16x32_bf16 v[68:71], v[156:159], v[164:167], v[68:71]
    ds_read_b64_tr_b16 v[156:157], v6 offset:5120
    ds_read_b64_tr_b16 v[158:159], v6 offset:5248
    ds_read_b128 v[160:163], v61 offset:2048
    ds_read_b128 v[164:167], v61 offset:18432
    s_waitcnt lgkmcnt(14)
    v_mfma_f32_16x16x32_bf16 v[72:75], v[168:171], v[200:203], v[72:75]
    s_waitcnt lgkmcnt(13)
    v_mfma_f32_16x16x32_bf16 v[64:67], v[168:171], v[172:175], v[64:67]
    s_waitcnt lgkmcnt(12)
    v_mfma_f32_16x16x32_bf16 v[68:71], v[168:171], v[176:179], v[68:71]
    ds_read_b64_tr_b16 v[168:169], v6 offset:6144
    ds_read_b64_tr_b16 v[170:171], v6 offset:6272
    ds_read_b128 v[172:175], v60 offset:3072
    ds_read_b128 v[176:179], v60 offset:19456
    s_waitcnt lgkmcnt(14)
    v_mfma_f32_16x16x32_bf16 v[72:75], v[180:183], v[200:203], v[72:75]
    s_waitcnt lgkmcnt(13)
    v_mfma_f32_16x16x32_bf16 v[64:67], v[180:183], v[184:187], v[64:67]
    s_waitcnt lgkmcnt(12)
    v_mfma_f32_16x16x32_bf16 v[68:71], v[180:183], v[188:191], v[68:71]
    ds_read_b64_tr_b16 v[180:181], v6 offset:7168
    ds_read_b64_tr_b16 v[182:183], v6 offset:7296
    ds_read_b128 v[184:187], v61 offset:3072
    ds_read_b128 v[188:191], v61 offset:19456
    s_waitcnt lgkmcnt(14)
    v_mfma_f32_16x16x32_bf16 v[72:75], v[144:147], v[200:203], v[72:75]
    s_waitcnt lgkmcnt(13)
    v_mfma_f32_16x16x32_bf16 v[64:67], v[144:147], v[148:151], v[64:67]
    s_waitcnt lgkmcnt(12)
    v_mfma_f32_16x16x32_bf16 v[68:71], v[144:147], v[152:155], v[68:71]
    ds_read_b64_tr_b16 v[144:145], v6 offset:10240
    ds_read_b64_tr_b16 v[146:147], v6 offset:10368
    ds_read_b128 v[148:151], v60 offset:4096
    ds_read_b128 v[152:155], v60 offset:20480
    s_waitcnt lgkmcnt(14)
    v_mfma_f32_16x16x32_bf16 v[72:75], v[156:159], v[200:203], v[72:75]
    s_waitcnt lgkmcnt(13)
    v_mfma_f32_16x16x32_bf16 v[64:67], v[156:159], v[160:163], v[64:67]
    s_waitcnt lgkmcnt(12)
    v_mfma_f32_16x16x32_bf16 v[68:71], v[156:159], v[164:167], v[68:71]
    ds_read_b64_tr_b16 v[156:157], v6 offset:11264
    ds_read_b64_tr_b16 v[158:159], v6 offset:11392
    ds_read_b128 v[160:163], v61 offset:4096
    ds_read_b128 v[164:167], v61 offset:20480
    s_waitcnt lgkmcnt(14)
    v_mfma_f32_16x16x32_bf16 v[72:75], v[168:171], v[200:203], v[72:75]
    s_waitcnt lgkmcnt(13)
    v_mfma_f32_16x16x32_bf16 v[64:67], v[168:171], v[172:175], v[64:67]
    s_waitcnt lgkmcnt(12)
    v_mfma_f32_16x16x32_bf16 v[68:71], v[168:171], v[176:179], v[68:71]
    ds_read_b64_tr_b16 v[168:169], v6 offset:12288
    ds_read_b64_tr_b16 v[170:171], v6 offset:12416
    ds_read_b128 v[172:175], v60 offset:5120
    ds_read_b128 v[176:179], v60 offset:21504
    s_waitcnt lgkmcnt(14)
    v_mfma_f32_16x16x32_bf16 v[72:75], v[180:183], v[200:203], v[72:75]
    s_waitcnt lgkmcnt(13)
    v_mfma_f32_16x16x32_bf16 v[64:67], v[180:183], v[184:187], v[64:67]
    s_waitcnt lgkmcnt(12)
    v_mfma_f32_16x16x32_bf16 v[68:71], v[180:183], v[188:191], v[68:71]
    ds_read_b64_tr_b16 v[180:181], v6 offset:13312
    ds_read_b64_tr_b16 v[182:183], v6 offset:13440
    ds_read_b128 v[184:187], v61 offset:5120
    ds_read_b128 v[188:191], v61 offset:21504
    s_waitcnt lgkmcnt(14)
    v_mfma_f32_16x16x32_bf16 v[72:75], v[144:147], v[200:203], v[72:75]
    s_waitcnt lgkmcnt(13)
    v_mfma_f32_16x16x32_bf16 v[64:67], v[144:147], v[148:151], v[64:67]
    s_waitcnt lgkmcnt(12)
    v_mfma_f32_16x16x32_bf16 v[68:71], v[144:147], v[152:155], v[68:71]
    ds_read_b64_tr_b16 v[144:145], v6 offset:14336
    ds_read_b64_tr_b16 v[146:147], v6 offset:14464
    ds_read_b128 v[148:151], v60 offset:6144
    ds_read_b128 v[152:155], v60 offset:22528
    s_waitcnt lgkmcnt(14)
    v_mfma_f32_16x16x32_bf16 v[72:75], v[156:159], v[200:203], v[72:75]
    s_waitcnt lgkmcnt(13)
    v_mfma_f32_16x16x32_bf16 v[64:67], v[156:159], v[160:163], v[64:67]
    s_waitcnt lgkmcnt(12)
    v_mfma_f32_16x16x32_bf16 v[68:71], v[156:159], v[164:167], v[68:71]
    ds_read_b64_tr_b16 v[156:157], v6 offset:15360
    ds_read_b64_tr_b16 v[158:159], v6 offset:15488
    ds_read_b128 v[160:163], v61 offset:6144
    ds_read_b128 v[164:167], v61 offset:22528
    s_waitcnt lgkmcnt(14)
    v_mfma_f32_16x16x32_bf16 v[72:75], v[168:171], v[200:203], v[72:75]
    s_waitcnt lgkmcnt(13)
    v_mfma_f32_16x16x32_bf16 v[64:67], v[168:171], v[172:175], v[64:67]
    s_waitcnt lgkmcnt(12)
    v_mfma_f32_16x16x32_bf16 v[68:71], v[168:171], v[176:179], v[68:71]
    ds_read_b64_tr_b16 v[168:169], v6 offset:16384
    ds_read_b64_tr_b16 v[170:171], v6 offset:16512
    ds_read_b128 v[172:175], v60 offset:7168
    ds_read_b128 v[176:179], v60 offset:23552
    s_waitcnt lgkmcnt(14)
    v_mfma_f32_16x16x32_bf16 v[72:75], v[180:183], v[200:203], v[72:75]
    s_waitcnt lgkmcnt(13)
    v_mfma_f32_16x16x32_bf16 v[64:67], v[180:183], v[184:187], v[64:67]
    s_waitcnt lgkmcnt(12)
    v_mfma_f32_16x16x32_bf16 v[68:71], v[180:183], v[188:191], v[68:71]
    ds_read_b64_tr_b16 v[180:181], v6 offset:17408
    ds_read_b64_tr_b16 v[182:183], v6 offset:17536
    ds_read_b128 v[184:187], v61 offset:7168
    ds_read_b128 v[188:191], v61 offset:23552
    s_waitcnt lgkmcnt(14)
    v_mfma_f32_16x16x32_bf16 v[72:75], v[144:147], v[200:203], v[72:75]
    s_waitcnt lgkmcnt(13)
    v_mfma_f32_16x16x32_bf16 v[64:67], v[144:147], v[148:151], v[64:67]
    s_waitcnt lgkmcnt(12)
    v_mfma_f32_16x16x32_bf16 v[68:71], v[144:147], v[152:155], v[68:71]
    s_waitcnt lgkmcnt(10)
    v_mfma_f32_16x16x32_bf16 v[72:75], v[156:159], v[200:203], v[72:75]
    s_waitcnt lgkmcnt(9)
    v_mfma_f32_16x16x32_bf16 v[64:67], v[156:159], v[160:163], v[64:67]
    s_waitcnt lgkmcnt(8)
    v_mfma_f32_16x16x32_bf16 v[68:71], v[156:159], v[164:167], v[68:71]
    v_lshl_add_u32 v57, v128, 2, s7
    ds_read2_b32 v[96:97], v57 offset0:0 offset1:16
    ds_read2_b32 v[104:105], v57 offset0:128 offset1:144
    v_and_b32 v131, 1, v129
    v_lshl_add_u32 v130, v131, 5, v128
    v_lshlrev_b32 v130, 4, v130
    v_lshrrev_b32 v131, 1, v129
    v_lshl_add_u32 v56, v131, 3, v130
    s_waitcnt lgkmcnt(8)
    v_mfma_f32_16x16x32_bf16 v[72:75], v[168:171], v[200:203], v[72:75]
    s_waitcnt lgkmcnt(7)
    v_mfma_f32_16x16x32_bf16 v[64:67], v[168:171], v[172:175], v[64:67]
    s_waitcnt lgkmcnt(6)
    v_mfma_f32_16x16x32_bf16 v[68:71], v[168:171], v[176:179], v[68:71]
    s_waitcnt lgkmcnt(4)
    v_mfma_f32_16x16x32_bf16 v[72:75], v[180:183], v[200:203], v[72:75]
    s_waitcnt lgkmcnt(3)
    v_mfma_f32_16x16x32_bf16 v[64:67], v[180:183], v[184:187], v[64:67]
    s_waitcnt lgkmcnt(2)
    v_mfma_f32_16x16x32_bf16 v[68:71], v[180:183], v[188:191], v[68:71]
    s_waitcnt lgkmcnt(0)
    s_nop 4
    v_fmac_f32 v64, v72, v104
    v_fmac_f32 v65, v73, v104
    v_fmac_f32 v66, v74, v104
    v_fmac_f32 v67, v75, v104
    v_mul_f32 v64, v64, v96
    v_mul_f32 v65, v65, v96
    v_mul_f32 v66, v66, v96
    v_mul_f32 v67, v67, v96
    v_cvt_pk_bf16_f32 v112, v64, v65
    v_cvt_pk_bf16_f32 v113, v66, v67
    buffer_store_dwordx2 v[112:113], v56, s[56:59], s10 offen offset:0 sc1
    v_fmac_f32 v68, v72, v105
    v_fmac_f32 v69, v73, v105
    v_fmac_f32 v70, v74, v105
    v_fmac_f32 v71, v75, v105
    v_mul_f32 v68, v68, v97
    v_mul_f32 v69, v69, v97
    v_mul_f32 v70, v70, v97
    v_mul_f32 v71, v71, v97
    v_cvt_pk_bf16_f32 v114, v68, v69
    v_cvt_pk_bf16_f32 v115, v70, v71
    buffer_store_dwordx2 v[114:115], v56, s[56:59], s10 offen offset:256 sc1
    s_waitcnt vmcnt(0) lgkmcnt(0)
    s_nop 0
    s_branch L_kvpub
L_doV:
    ds_read_b64_tr_b16 v[144:145], v6 offset:0
    ds_read_b64_tr_b16 v[146:147], v6 offset:128
    ds_read_b128 v[148:151], v60 offset:0
    ds_read_b128 v[152:155], v60 offset:16384
    ds_read_b64_tr_b16 v[156:157], v6 offset:1024
    ds_read_b64_tr_b16 v[158:159], v6 offset:1152
    ds_read_b128 v[160:163], v61 offset:0
    ds_read_b128 v[164:167], v61 offset:16384
    ds_read_b64_tr_b16 v[168:169], v6 offset:2048
    ds_read_b64_tr_b16 v[170:171], v6 offset:2176
    ds_read_b128 v[172:175], v60 offset:1024
    ds_read_b128 v[176:179], v60 offset:17408
    ds_read_b64_tr_b16 v[180:181], v6 offset:3072
    ds_read_b64_tr_b16 v[182:183], v6 offset:3200
    ds_read_b128 v[184:187], v61 offset:1024
    ds_read_b128 v[188:191], v61 offset:17408
    s_waitcnt lgkmcnt(14)
    v_mfma_f32_16x16x32_bf16 v[72:75], v[200:203], v[144:147], 0
    s_waitcnt lgkmcnt(13)
    v_mfma_f32_16x16x32_bf16 v[64:67], v[148:151], v[144:147], 0
    s_waitcnt lgkmcnt(12)
    v_mfma_f32_16x16x32_bf16 v[68:71], v[152:155], v[144:147], 0
    ds_read_b64_tr_b16 v[144:145], v6 offset:4096
    ds_read_b64_tr_b16 v[146:147], v6 offset:4224
    ds_read_b128 v[148:151], v60 offset:2048
    ds_read_b128 v[152:155], v60 offset:18432
    s_waitcnt lgkmcnt(14)
    v_mfma_f32_16x16x32_bf16 v[72:75], v[200:203], v[156:159], v[72:75]
    s_waitcnt lgkmcnt(13)
    v_mfma_f32_16x16x32_bf16 v[64:67], v[160:163], v[156:159], v[64:67]
    s_waitcnt lgkmcnt(12)
    v_mfma_f32_16x16x32_bf16 v[68:71], v[164:167], v[156:159], v[68:71]
    ds_read_b64_tr_b16 v[156:157], v6 offset:5120
    ds_read_b64_tr_b16 v[158:159], v6 offset:5248
    ds_read_b128 v[160:163], v61 offset:2048
    ds_read_b128 v[164:167], v61 offset:18432
    s_waitcnt lgkmcnt(14)
    v_mfma_f32_16x16x32_bf16 v[72:75], v[200:203], v[168:171], v[72:75]
    s_waitcnt lgkmcnt(13)
    v_mfma_f32_16x16x32_bf16 v[64:67], v[172:175], v[168:171], v[64:67]
    s_waitcnt lgkmcnt(12)
    v_mfma_f32_16x16x32_bf16 v[68:71], v[176:179], v[168:171], v[68:71]
    ds_read_b64_tr_b16 v[168:169], v6 offset:6144
    ds_read_b64_tr_b16 v[170:171], v6 offset:6272
    ds_read_b128 v[172:175], v60 offset:3072
    ds_read_b128 v[176:179], v60 offset:19456
    s_waitcnt lgkmcnt(14)
    v_mfma_f32_16x16x32_bf16 v[72:75], v[200:203], v[180:183], v[72:75]
    s_waitcnt lgkmcnt(13)
    v_mfma_f32_16x16x32_bf16 v[64:67], v[184:187], v[180:183], v[64:67]
    s_waitcnt lgkmcnt(12)
    v_mfma_f32_16x16x32_bf16 v[68:71], v[188:191], v[180:183], v[68:71]
    ds_read_b64_tr_b16 v[180:181], v6 offset:7168
    ds_read_b64_tr_b16 v[182:183], v6 offset:7296
    ds_read_b128 v[184:187], v61 offset:3072
    ds_read_b128 v[188:191], v61 offset:19456
    s_waitcnt lgkmcnt(14)
    v_mfma_f32_16x16x32_bf16 v[72:75], v[200:203], v[144:147], v[72:75]
    s_waitcnt lgkmcnt(13)
    v_mfma_f32_16x16x32_bf16 v[64:67], v[148:151], v[144:147], v[64:67]
    s_waitcnt lgkmcnt(12)
    v_mfma_f32_16x16x32_bf16 v[68:71], v[152:155], v[144:147], v[68:71]
    ds_read_b64_tr_b16 v[144:145], v6 offset:10240
    ds_read_b64_tr_b16 v[146:147], v6 offset:10368
    ds_read_b128 v[148:151], v60 offset:4096
    ds_read_b128 v[152:155], v60 offset:20480
    s_waitcnt lgkmcnt(14)
    v_mfma_f32_16x16x32_bf16 v[72:75], v[200:203], v[156:159], v[72:75]
    s_waitcnt lgkmcnt(13)
    v_mfma_f32_16x16x32_bf16 v[64:67], v[160:163], v[156:159], v[64:67]
    s_waitcnt lgkmcnt(12)
    v_mfma_f32_16x16x32_bf16 v[68:71], v[164:167], v[156:159], v[68:71]
    ds_read_b64_tr_b16 v[156:157], v6 offset:11264
    ds_read_b64_tr_b16 v[158:159], v6 offset:11392
    ds_read_b128 v[160:163], v61 offset:4096
    ds_read_b128 v[164:167], v61 offset:20480
    s_waitcnt lgkmcnt(14)
    v_mfma_f32_16x16x32_bf16 v[72:75], v[200:203], v[168:171], v[72:75]
    s_waitcnt lgkmcnt(13)
    v_mfma_f32_16x16x32_bf16 v[64:67], v[172:175], v[168:171], v[64:67]
    s_waitcnt lgkmcnt(12)
    v_mfma_f32_16x16x32_bf16 v[68:71], v[176:179], v[168:171], v[68:71]
    ds_read_b64_tr_b16 v[168:169], v6 offset:12288
    ds_read_b64_tr_b16 v[170:171], v6 offset:12416
    ds_read_b128 v[172:175], v60 offset:5120
    ds_read_b128 v[176:179], v60 offset:21504
    s_waitcnt lgkmcnt(14)
    v_mfma_f32_16x16x32_bf16 v[72:75], v[200:203], v[180:183], v[72:75]
    s_waitcnt lgkmcnt(13)
    v_mfma_f32_16x16x32_bf16 v[64:67], v[184:187], v[180:183], v[64:67]
    s_waitcnt lgkmcnt(12)
    v_mfma_f32_16x16x32_bf16 v[68:71], v[188:191], v[180:183], v[68:71]
    ds_read_b64_tr_b16 v[180:181], v6 offset:13312
    ds_read_b64_tr_b16 v[182:183], v6 offset:13440
    ds_read_b128 v[184:187], v61 offset:5120
    ds_read_b128 v[188:191], v61 offset:21504
    s_waitcnt lgkmcnt(14)
    v_mfma_f32_16x16x32_bf16 v[72:75], v[200:203], v[144:147], v[72:75]
    s_waitcnt lgkmcnt(13)
    v_mfma_f32_16x16x32_bf16 v[64:67], v[148:151], v[144:147], v[64:67]
    s_waitcnt lgkmcnt(12)
    v_mfma_f32_16x16x32_bf16 v[68:71], v[152:155], v[144:147], v[68:71]
    ds_read_b64_tr_b16 v[144:145], v6 offset:14336
    ds_read_b64_tr_b16 v[146:147], v6 offset:14464
    ds_read_b128 v[148:151], v60 offset:6144
    ds_read_b128 v[152:155], v60 offset:22528
    s_waitcnt lgkmcnt(14)
    v_mfma_f32_16x16x32_bf16 v[72:75], v[200:203], v[156:159], v[72:75]
    s_waitcnt lgkmcnt(13)
    v_mfma_f32_16x16x32_bf16 v[64:67], v[160:163], v[156:159], v[64:67]
    s_waitcnt lgkmcnt(12)
    v_mfma_f32_16x16x32_bf16 v[68:71], v[164:167], v[156:159], v[68:71]
    ds_read_b64_tr_b16 v[156:157], v6 offset:15360
    ds_read_b64_tr_b16 v[158:159], v6 offset:15488
    ds_read_b128 v[160:163], v61 offset:6144
    ds_read_b128 v[164:167], v61 offset:22528
    s_waitcnt lgkmcnt(14)
    v_mfma_f32_16x16x32_bf16 v[72:75], v[200:203], v[168:171], v[72:75]
    s_waitcnt lgkmcnt(13)
    v_mfma_f32_16x16x32_bf16 v[64:67], v[172:175], v[168:171], v[64:67]
    s_waitcnt lgkmcnt(12)
    v_mfma_f32_16x16x32_bf16 v[68:71], v[176:179], v[168:171], v[68:71]
    ds_read_b64_tr_b16 v[168:169], v6 offset:16384
    ds_read_b64_tr_b16 v[170:171], v6 offset:16512
    ds_read_b128 v[172:175], v60 offset:7168
    ds_read_b128 v[176:179], v60 offset:23552
    s_waitcnt lgkmcnt(14)
    v_mfma_f32_16x16x32_bf16 v[72:75], v[200:203], v[180:183], v[72:75]
    s_waitcnt lgkmcnt(13)
    v_mfma_f32_16x16x32_bf16 v[64:67], v[184:187], v[180:183], v[64:67]
    s_waitcnt lgkmcnt(12)
    v_mfma_f32_16x16x32_bf16 v[68:71], v[188:191], v[180:183], v[68:71]
    ds_read_b64_tr_b16 v[180:181], v6 offset:17408
    ds_read_b64_tr_b16 v[182:183], v6 offset:17536
    ds_read_b128 v[184:187], v61 offset:7168
    ds_read_b128 v[188:191], v61 offset:23552
    s_waitcnt lgkmcnt(14)
    v_mfma_f32_16x16x32_bf16 v[72:75], v[200:203], v[144:147], v[72:75]
    s_waitcnt lgkmcnt(13)
    v_mfma_f32_16x16x32_bf16 v[64:67], v[148:151], v[144:147], v[64:67]
    s_waitcnt lgkmcnt(12)
    v_mfma_f32_16x16x32_bf16 v[68:71], v[152:155], v[144:147], v[68:71]
    s_waitcnt lgkmcnt(10)
    v_mfma_f32_16x16x32_bf16 v[72:75], v[200:203], v[156:159], v[72:75]
    s_waitcnt lgkmcnt(9)
    v_mfma_f32_16x16x32_bf16 v[64:67], v[160:163], v[156:159], v[64:67]
    s_waitcnt lgkmcnt(8)
    v_mfma_f32_16x16x32_bf16 v[68:71], v[164:167], v[156:159], v[68:71]
    v_lshl_add_u32 v57, v129, 4, s7
    ds_read_b128 v[96:99], v57 offset:0
    ds_read_b128 v[104:107], v57 offset:512
    ds_read_b128 v[100:103], v57 offset:64
    ds_read_b128 v[108:111], v57 offset:576
    v_lshrrev_b32 v130, 1, v129
    v_lshl_add_u32 v130, v130, 4, v128
    v_lshlrev_b32 v130, 4, v130
    v_and_b32 v131, 1, v129
    v_lshl_add_u32 v56, v131, 3, v130
    s_add_u32 s10, s10, 65536
    s_waitcnt lgkmcnt(10)
    v_mfma_f32_16x16x32_bf16 v[72:75], v[200:203], v[168:171], v[72:75]
    s_waitcnt lgkmcnt(9)
    v_mfma_f32_16x16x32_bf16 v[64:67], v[172:175], v[168:171], v[64:67]
    s_waitcnt lgkmcnt(8)
    v_mfma_f32_16x16x32_bf16 v[68:71], v[176:179], v[168:171], v[68:71]
    s_waitcnt lgkmcnt(6)
    v_mfma_f32_16x16x32_bf16 v[72:75], v[200:203], v[180:183], v[72:75]
    s_waitcnt lgkmcnt(5)
    v_mfma_f32_16x16x32_bf16 v[64:67], v[184:187], v[180:183], v[64:67]
    s_waitcnt lgkmcnt(4)
    v_mfma_f32_16x16x32_bf16 v[68:71], v[188:191], v[180:183], v[68:71]
    s_waitcnt lgkmcnt(2)
    s_nop 4
    v_fmac_f32 v64, v72, v104
    v_fmac_f32 v65, v73, v105
    v_fmac_f32 v66, v74, v106
    v_fmac_f32 v67, v75, v107
    v_mul_f32 v64, v64, v96
    v_mul_f32 v65, v65, v97
    v_mul_f32 v66, v66, v98
    v_mul_f32 v67, v67, v99
    v_cvt_pk_bf16_f32 v112, v64, v65
    v_cvt_pk_bf16_f32 v113, v66, v67
    buffer_store_dwordx2 v[112:113], v56, s[56:59], s10 offen offset:0 sc1
    s_waitcnt lgkmcnt(0)
    v_fmac_f32 v68, v72, v108
    v_fmac_f32 v69, v73, v109
    v_fmac_f32 v70, v74, v110
    v_fmac_f32 v71, v75, v111
    v_mul_f32 v68, v68, v100
    v_mul_f32 v69, v69, v101
    v_mul_f32 v70, v70, v102
    v_mul_f32 v71, v71, v103
    v_cvt_pk_bf16_f32 v114, v68, v69
    v_cvt_pk_bf16_f32 v115, v70, v71
    buffer_store_dwordx2 v[114:115], v56, s[56:59], s10 offen offset:512 sc1
    s_waitcnt vmcnt(0) lgkmcnt(0)
    s_nop 0
L_kvpub:
    v_readfirstlane_b32 s84, v1
    s_nop 1
    s_mul_i32 s84, s84, 0x9e3779b1
    s_add_u32 s84, s84, 0x7f4a7c15
    v_mov_b32 v15, 158208
    v_mov_b32 v52, 1
    s_mov_b64 exec, 1
    ds_add_rtn_u32 v53, v15, v52
    s_mov_b64 exec, -1
    s_lshl_b32 s8, s4, 7
    s_add_u32 s8, s8, 135168
    s_waitcnt lgkmcnt(0)
    v_readfirstlane_b32 s7, v53
    s_nop 1
    s_cmp_lg_u32 s7, 3
    s_cbranch_scc1 L_noflag1
    v_mov_b32 v136, s84
    s_mov_b64 exec, 1
    buffer_store_dword v136, v5, s[56:59], s8 offen sc1
    s_mov_b64 exec, -1
    s_nop 0
L_noflag1:
    s_barrier
L_idle:
    s_waitcnt vmcnt(0) lgkmcnt(0)
    v_readfirstlane_b32 s84, v1
    s_nop 1
    s_mul_i32 s84, s84, 0x9e3779b1
    s_add_u32 s84, s84, 0x7f4a7c15
    s_mov_b32 s73, 0
L_done:
    s_cmp_ge_u32 s3, 2
    s_cbranch_scc1 L_late
    s_cmp_eq_u32 s73, 1
    s_cbranch_scc1 L_kvdone
    s_mov_b32 s86, 0
L_poll1:
    s_mov_b32 s85, 135168
    buffer_load_dword v132, v10, s[56:59], s85 offen sc1
    s_add_u32 s86, s86, 1
    s_waitcnt vmcnt(0)
    v_cmp_eq_u32 vcc, s84, v132
    s_nop 1
    s_cmp_eq_u64 vcc, exec
    s_nop 1
    s_cbranch_scc1 L_poll1_ok
    s_sleep 2
    s_cmp_lt_u32 s86, 200000
    s_cbranch_scc1 L_poll1
L_poll1_ok:
    s_and_b32 s10, s3, 1
    s_lshl_b32 s10, s10, 15
    s_lshr_b32 s12, s3, 1
    s_lshl_b32 s12, s12, 2
    s_add_u32 s12, s12, s75
    s_add_u32 s11, s12, 0
    s_and_b32 s11, s11, 31
    s_lshl_b32 s11, s11, 10
    s_add_u32 s11, s11, s10
    s_add_u32 m0, s14, 0
    s_add_u32 s13, s11, 65536
    buffer_load_dwordx4 v5, s[56:59], s11 offen sc1 lds
    s_add_u32 m0, s14, 1024
    s_nop 0
    buffer_load_dwordx4 v5, s[56:59], s13 offen sc1 lds
    s_add_u32 s11, s12, 1
    s_and_b32 s11, s11, 31
    s_lshl_b32 s11, s11, 10
    s_add_u32 s11, s11, s10
    s_add_u32 m0, s14, 2064
    s_add_u32 s13, s11, 65536
    buffer_load_dwordx4 v5, s[56:59], s11 offen sc1 lds
    s_add_u32 m0, s14, 3088
    s_nop 0
    buffer_load_dwordx4 v5, s[56:59], s13 offen sc1 lds
    s_add_u32 s11, s12, 2
    s_and_b32 s11, s11, 31
    s_lshl_b32 s11, s11, 10
    s_add_u32 s11, s11, s10
    s_add_u32 m0, s14, 4128
    s_add_u32 s13, s11, 65536
    buffer_load_dwordx4 v5, s[56:59], s11 offen sc1 lds
    s_add_u32 m0, s14, 5152
    s_nop 0
    buffer_load_dwordx4 v5, s[56:59], s13 offen sc1 lds
    s_add_u32 s11, s12, 3
    s_and_b32 s11, s11, 31
    s_lshl_b32 s11, s11, 10
    s_add_u32 s11, s11, s10
    s_add_u32 m0, s14, 6192
    s_add_u32 s13, s11, 65536
    buffer_load_dwordx4 v5, s[56:59], s11 offen sc1 lds
    s_add_u32 m0, s14, 7216
    s_nop 0
    buffer_load_dwordx4 v5, s[56:59], s13 offen sc1 lds
    v_mov_b32 v136, 0x3f803f80
    v_mov_b32 v137, 0x3f803f80
    v_mov_b32 v138, 0x3f803f80
    v_mov_b32 v139, 0x3f803f80
    v_and_b32 v140, 3, v0
    v_mul_u32_u24 v140, 2064, v140
    v_add_u32 v140, s14, v140
    ds_write_b128 v140, v[136:139] offset:2048
    s_nop 0
L_kvdone:
    s_waitcnt vmcnt(0)
L_late:
    s_waitcnt lgkmcnt(0)
    s_barrier
    s_and_b32 s6, s3, 3
    s_lshr_b32 s7, s3, 2
    v_mov_b32 v100, 0xdddddddd
    s_lshl_b32 s15, s7, 11
    s_sub_u32 s15, 1024, s15
    v_add_u32 v101, s15, v247
    ds_read_b128 v[80:83], v101
    ds_read_b128 v[88:91], v244 offset:0
    ds_read_b128 v[84:87], v247
    ds_read_b128 v[92:95], v245 offset:0
    ds_read_b128 v[96:99], v246 offset:0
    s_waitcnt lgkmcnt(3)
    v_mfma_f32_32x32x16_bf16 v[16:31], v[88:91], v[80:83], 0
    s_setprio 0
    s_nop 10
    v_exp_f32 v16, v16
    v_exp_f32 v17, v17
    v_exp_f32 v18, v18
    v_exp_f32 v19, v19
    v_exp_f32 v20, v20
    s_waitcnt lgkmcnt(2)
    v_mfma_f32_32x32x16_bf16 v[32:47], v[88:91], v[84:87], 0
    ds_read_b128 v[88:91], v244 offset:2064
    v_exp_f32 v21, v21
    v_exp_f32 v22, v22
    s_cmp_lt_u32 s3, 2
    s_cbranch_scc1 L_skipkv0
    s_and_b32 s10, s3, 1
    s_lshl_b32 s10, s10, 15
    s_lshr_b32 s12, s3, 1
    s_lshl_b32 s12, s12, 2
    s_add_u32 s12, s12, s75
    s_add_u32 s11, s12, 0
    s_and_b32 s11, s11, 31
    s_lshl_b32 s11, s11, 10
    s_add_u32 s11, s11, s10
    s_add_u32 m0, s14, 0
    s_add_u32 s13, s11, 65536
    buffer_load_dwordx4 v5, s[56:59], s11 offen sc1 lds
    s_add_u32 m0, s14, 1024
    s_nop 0
    buffer_load_dwordx4 v5, s[56:59], s13 offen sc1 lds
L_skipkv0:
    v_exp_f32 v23, v23
    v_exp_f32 v24, v24
    v_exp_f32 v25, v25
    s_waitcnt lgkmcnt(2)
    v_smfmac_f32_32x32x32_bf16 v[212:227], v[92:95], v[16:23], v100
    s_setprio 1
    v_exp_f32 v26, v26
    v_exp_f32 v27, v27
    v_exp_f32 v28, v28
    v_exp_f32 v29, v29
    v_exp_f32 v30, v30
    s_cmp_lt_u32 s3, 2
    s_cbranch_scc1 L_skipkv1
    s_add_u32 s11, s12, 1
    s_and_b32 s11, s11, 31
    s_lshl_b32 s11, s11, 10
    s_add_u32 s11, s11, s10
    s_add_u32 m0, s14, 2064
    s_add_u32 s13, s11, 65536
    buffer_load_dwordx4 v5, s[56:59], s11 offen sc1 lds
    s_add_u32 m0, s14, 3088
    s_nop 0
    buffer_load_dwordx4 v5, s[56:59], s13 offen sc1 lds
L_skipkv1:
    v_exp_f32 v31, v31
    v_exp_f32 v32, v32
    v_exp_f32 v33, v33
    s_waitcnt lgkmcnt(1)
    v_smfmac_f32_32x32x32_bf16 v[212:227], v[96:99], v[24:31], v100
    v_exp_f32 v34, v34
    v_exp_f32 v35, v35
    v_exp_f32 v36, v36
    s_waitcnt lgkmcnt(0)
    v_mfma_f32_32x32x16_bf16 v[16:31], v[88:91], v[80:83], 0
    v_exp_f32 v37, v37
    v_exp_f32 v38, v38
    s_cmp_lt_u32 s3, 2
    s_cbranch_scc1 L_skipkv2
    s_add_u32 s11, s12, 2
    s_and_b32 s11, s11, 31
    s_lshl_b32 s11, s11, 10
    s_add_u32 s11, s11, s10
    s_add_u32 m0, s14, 4128
    s_add_u32 s13, s11, 65536
    buffer_load_dwordx4 v5, s[56:59], s11 offen sc1 lds
    s_add_u32 m0, s14, 5152
    s_nop 0
    buffer_load_dwordx4 v5, s[56:59], s13 offen sc1 lds
L_skipkv2:
    v_exp_f32 v39, v39
    v_exp_f32 v40, v40
    v_exp_f32 v41, v41
    v_smfmac_f32_32x32x32_bf16 v[228:243], v[92:95], v[32:39], v100
    ds_read_b128 v[92:95], v245 offset:2064
    v_exp_f32 v42, v42
    v_exp_f32 v43, v43
    v_exp_f32 v44, v44
    v_exp_f32 v45, v45
    v_exp_f32 v46, v46
    s_cmp_lt_u32 s3, 2
    s_cbranch_scc1 L_skipkv3
    s_add_u32 s11, s12, 3
    s_and_b32 s11, s11, 31
    s_lshl_b32 s11, s11, 10
    s_add_u32 s11, s11, s10
    s_add_u32 m0, s14, 6192
    s_add_u32 s13, s11, 65536
    buffer_load_dwordx4 v5, s[56:59], s11 offen sc1 lds
    s_add_u32 m0, s14, 7216
    s_nop 0
    buffer_load_dwordx4 v5, s[56:59], s13 offen sc1 lds
    v_mov_b32 v136, 0x3f803f80
    v_mov_b32 v137, 0x3f803f80
    v_mov_b32 v138, 0x3f803f80
    v_mov_b32 v139, 0x3f803f80
    v_and_b32 v101, 3, v0
    v_mul_u32_u24 v101, 2064, v101
    v_add_u32 v101, s14, v101
    ds_write_b128 v101, v[136:139] offset:2048
L_skipkv3:
    v_exp_f32 v47, v47
    s_setprio 0
    v_exp_f32 v16, v16
    v_exp_f32 v17, v17
    v_smfmac_f32_32x32x32_bf16 v[228:243], v[96:99], v[40:47], v100
    ds_read_b128 v[96:99], v246 offset:2064
    v_exp_f32 v18, v18
    v_exp_f32 v19, v19
    v_exp_f32 v20, v20
    v_mfma_f32_32x32x16_bf16 v[32:47], v[88:91], v[84:87], 0
    ds_read_b128 v[88:91], v244 offset:4128
    v_exp_f32 v21, v21
    v_exp_f32 v22, v22
    v_exp_f32 v23, v23
    v_exp_f32 v24, v24
    v_exp_f32 v25, v25
    s_waitcnt lgkmcnt(2)
    v_smfmac_f32_32x32x32_bf16 v[212:227], v[92:95], v[16:23], v100
    s_setprio 1
    v_exp_f32 v26, v26
    v_exp_f32 v27, v27
    v_exp_f32 v28, v28
    v_exp_f32 v29, v29
    v_exp_f32 v30, v30
    s_lshl_b32 s90, s5, 2
    s_and_b32 s15, s6, 2
    s_add_u32 s90, s90, s15
    s_add_u32 s90, s90, s7
    s_lshl_b32 s90, s90, 1
    s_and_b32 s15, s6, 1
    s_add_u32 s90, s90, s15
    s_lshl_b32 s90, s90, 10
    s_lshl_b32 s15, s4, 16
    s_add_u32 s15, s15, s90
    s_add_u32 s15, s15, 13631488
    v_mov_b32 v48, -1
    v_mov_b32 v49, -1
    v_mov_b32 v50, -1
    v_mov_b32 v51, -1
    buffer_store_dwordx4 v[48:51], v5, s[56:59], s15 offen sc1
    v_exp_f32 v31, v31
    v_exp_f32 v32, v32
    v_exp_f32 v33, v33
    s_waitcnt lgkmcnt(1)
    v_smfmac_f32_32x32x32_bf16 v[212:227], v[96:99], v[24:31], v100
    v_exp_f32 v34, v34
    v_exp_f32 v35, v35
    v_exp_f32 v36, v36
    s_waitcnt lgkmcnt(0)
    v_mfma_f32_32x32x16_bf16 v[16:31], v[88:91], v[80:83], 0
    v_exp_f32 v37, v37
    v_exp_f32 v38, v38
    v_exp_f32 v39, v39
    v_exp_f32 v40, v40
    v_exp_f32 v41, v41
    v_smfmac_f32_32x32x32_bf16 v[228:243], v[92:95], v[32:39], v100
    ds_read_b128 v[92:95], v245 offset:4128
    v_exp_f32 v42, v42
    v_exp_f32 v43, v43
    v_exp_f32 v44, v44
    v_exp_f32 v45, v45
    v_exp_f32 v46, v46
    v_exp_f32 v47, v47
    s_setprio 0
    v_exp_f32 v16, v16
    v_exp_f32 v17, v17
    v_smfmac_f32_32x32x32_bf16 v[228:243], v[96:99], v[40:47], v100
    ds_read_b128 v[96:99], v246 offset:4128
    v_exp_f32 v18, v18
    v_exp_f32 v19, v19
    v_exp_f32 v20, v20
    v_mfma_f32_32x32x16_bf16 v[32:47], v[88:91], v[84:87], 0
    ds_read_b128 v[88:91], v244 offset:6192
    v_exp_f32 v21, v21
    v_exp_f32 v22, v22
    v_exp_f32 v23, v23
    v_exp_f32 v24, v24
    v_exp_f32 v25, v25
    s_waitcnt lgkmcnt(2)
    v_smfmac_f32_32x32x32_bf16 v[212:227], v[92:95], v[16:23], v100
    s_setprio 1
    v_exp_f32 v26, v26
    v_exp_f32 v27, v27
    v_exp_f32 v28, v28
    v_exp_f32 v29, v29
    v_exp_f32 v30, v30
    v_exp_f32 v31, v31
    v_exp_f32 v32, v32
    v_exp_f32 v33, v33
    s_waitcnt lgkmcnt(1)
    v_smfmac_f32_32x32x32_bf16 v[212:227], v[96:99], v[24:31], v100
    v_exp_f32 v34, v34
    v_exp_f32 v35, v35
    v_exp_f32 v36, v36
    s_waitcnt lgkmcnt(0)
    v_mfma_f32_32x32x16_bf16 v[16:31], v[88:91], v[80:83], 0
    v_exp_f32 v37, v37
    v_exp_f32 v38, v38
    v_exp_f32 v39, v39
    v_exp_f32 v40, v40
    v_exp_f32 v41, v41
    v_smfmac_f32_32x32x32_bf16 v[228:243], v[92:95], v[32:39], v100
    ds_read_b128 v[92:95], v245 offset:6192
    v_exp_f32 v42, v42
    v_exp_f32 v43, v43
    v_exp_f32 v44, v44
    v_exp_f32 v45, v45
    v_exp_f32 v46, v46
    v_exp_f32 v47, v47
    s_waitcnt vmcnt(0) lgkmcnt(0)
    s_barrier
    s_setprio 0
    v_exp_f32 v16, v16
    v_exp_f32 v17, v17
    v_smfmac_f32_32x32x32_bf16 v[228:243], v[96:99], v[40:47], v100
    ds_read_b128 v[96:99], v246 offset:6192
    v_exp_f32 v18, v18
    v_exp_f32 v19, v19
    v_exp_f32 v20, v20
    v_mfma_f32_32x32x16_bf16 v[32:47], v[88:91], v[84:87], 0
    ds_read_b128 v[88:91], v244 offset:20480
    v_exp_f32 v21, v21
    v_exp_f32 v22, v22
    s_mul_i32 s87, s7, 4294944512
    s_add_u32 s87, s87, 107008
    s_lshl_b32 s10, s7, 4
    s_add_u32 s10, s10, s6
    s_mul_i32 s14, s10, 2064
    s_lshl_b32 s10, s7, 15
    s_add_u32 s12, s6, s75
    s_add_u32 s11, s12, 16
    s_and_b32 s11, s11, 31
    s_lshl_b32 s11, s11, 10
    s_add_u32 s11, s11, s10
    s_add_u32 m0, s14, 0
    s_nop 0
    buffer_load_dwordx4 v5, s[56:59], s11 offen sc1 lds
    v_exp_f32 v23, v23
    v_exp_f32 v24, v24
    v_exp_f32 v25, v25
    v_smfmac_f32_32x32x32_bf16 v[212:227], v[92:95], v[16:23], v100
    s_setprio 1
    v_exp_f32 v26, v26
    v_exp_f32 v27, v27
    v_exp_f32 v28, v28
    v_exp_f32 v29, v29
    v_exp_f32 v30, v30
    s_add_u32 s11, s11, 65536
    s_add_u32 m0, s14, 1024
    s_nop 0
    buffer_load_dwordx4 v5, s[56:59], s11 offen sc1 lds
    v_exp_f32 v31, v31
    v_exp_f32 v32, v32
    v_exp_f32 v33, v33
    s_waitcnt lgkmcnt(1)
    v_smfmac_f32_32x32x32_bf16 v[212:227], v[96:99], v[24:31], v100
    v_exp_f32 v34, v34
    v_exp_f32 v35, v35
    v_exp_f32 v36, v36
    s_waitcnt lgkmcnt(0)
    v_mfma_f32_32x32x16_bf16 v[16:31], v[88:91], v[80:83], 0
    v_exp_f32 v37, v37
    v_exp_f32 v38, v38
    s_add_u32 s11, s12, 20
    s_and_b32 s11, s11, 31
    s_lshl_b32 s11, s11, 10
    s_add_u32 s11, s11, s10
    s_add_u32 m0, s14, 8256
    s_nop 0
    buffer_load_dwordx4 v5, s[56:59], s11 offen sc1 lds
    v_exp_f32 v39, v39
    v_exp_f32 v40, v40
    v_exp_f32 v41, v41
    v_smfmac_f32_32x32x32_bf16 v[228:243], v[92:95], v[32:39], v100
    ds_read_b128 v[92:95], v245 offset:20480
    v_exp_f32 v42, v42
    v_exp_f32 v43, v43
    v_exp_f32 v44, v44
    v_exp_f32 v45, v45
    v_exp_f32 v46, v46
    s_add_u32 s11, s11, 65536
    s_add_u32 m0, s14, 9280
    s_nop 0
    buffer_load_dwordx4 v5, s[56:59], s11 offen sc1 lds
    v_exp_f32 v47, v47
    s_setprio 0
    v_exp_f32 v16, v16
    v_exp_f32 v17, v17
    v_smfmac_f32_32x32x32_bf16 v[228:243], v[96:99], v[40:47], v100
    ds_read_b128 v[96:99], v246 offset:20480
    v_exp_f32 v18, v18
    v_exp_f32 v19, v19
    v_exp_f32 v20, v20
    v_mfma_f32_32x32x16_bf16 v[32:47], v[88:91], v[84:87], 0
    ds_read_b128 v[88:91], v244 offset:22544
    v_exp_f32 v21, v21
    v_exp_f32 v22, v22
    s_add_u32 s11, s12, 24
    s_and_b32 s11, s11, 31
    s_lshl_b32 s11, s11, 10
    s_add_u32 s11, s11, s10
    s_add_u32 m0, s14, 16512
    s_nop 0
    buffer_load_dwordx4 v5, s[56:59], s11 offen sc1 lds
    v_exp_f32 v23, v23
    v_exp_f32 v24, v24
    v_exp_f32 v25, v25
    s_waitcnt lgkmcnt(2)
    v_smfmac_f32_32x32x32_bf16 v[212:227], v[92:95], v[16:23], v100
    s_setprio 1
    v_exp_f32 v26, v26
    v_exp_f32 v27, v27
    v_exp_f32 v28, v28
    v_exp_f32 v29, v29
    v_exp_f32 v30, v30
    s_add_u32 s11, s11, 65536
    s_add_u32 m0, s14, 17536
    s_nop 0
    buffer_load_dwordx4 v5, s[56:59], s11 offen sc1 lds
    v_exp_f32 v31, v31
    v_exp_f32 v32, v32
    v_exp_f32 v33, v33
    s_waitcnt lgkmcnt(1)
    v_smfmac_f32_32x32x32_bf16 v[212:227], v[96:99], v[24:31], v100
    v_exp_f32 v34, v34
    v_exp_f32 v35, v35
    v_exp_f32 v36, v36
    s_waitcnt lgkmcnt(0)
    v_mfma_f32_32x32x16_bf16 v[16:31], v[88:91], v[80:83], 0
    v_exp_f32 v37, v37
    v_exp_f32 v38, v38
    s_add_u32 s11, s12, 28
    s_and_b32 s11, s11, 31
    s_lshl_b32 s11, s11, 10
    s_add_u32 s11, s11, s10
    s_add_u32 m0, s14, 24768
    s_nop 0
    buffer_load_dwordx4 v5, s[56:59], s11 offen sc1 lds
    v_exp_f32 v39, v39
    v_exp_f32 v40, v40
    v_exp_f32 v41, v41
    v_smfmac_f32_32x32x32_bf16 v[228:243], v[92:95], v[32:39], v100
    ds_read_b128 v[92:95], v245 offset:22544
    v_exp_f32 v42, v42
    v_exp_f32 v43, v43
    v_exp_f32 v44, v44
    v_exp_f32 v45, v45
    v_exp_f32 v46, v46
    s_add_u32 s11, s11, 65536
    s_add_u32 m0, s14, 25792
    s_nop 0
    buffer_load_dwordx4 v5, s[56:59], s11 offen sc1 lds
    v_and_b32 v101, 3, v0
    v_mul_u32_u24 v101, 8256, v101
    v_add_u32 v101, s14, v101
    ds_write_b128 v101, v[136:139] offset:2048
    v_exp_f32 v47, v47
    s_setprio 0
    v_exp_f32 v16, v16
    v_exp_f32 v17, v17
    v_smfmac_f32_32x32x32_bf16 v[228:243], v[96:99], v[40:47], v100
    ds_read_b128 v[96:99], v246 offset:22544
    v_exp_f32 v18, v18
    v_exp_f32 v19, v19
    v_exp_f32 v20, v20
    v_mfma_f32_32x32x16_bf16 v[32:47], v[88:91], v[84:87], 0
    ds_read_b128 v[88:91], v244 offset:24608
    v_exp_f32 v21, v21
    v_exp_f32 v22, v22
    v_exp_f32 v23, v23
    v_exp_f32 v24, v24
    v_exp_f32 v25, v25
    s_waitcnt lgkmcnt(3)
    v_smfmac_f32_32x32x32_bf16 v[212:227], v[92:95], v[16:23], v100
    s_setprio 1
    v_exp_f32 v26, v26
    v_exp_f32 v27, v27
    v_exp_f32 v28, v28
    v_exp_f32 v29, v29
    v_exp_f32 v30, v30
    v_exp_f32 v31, v31
    v_exp_f32 v32, v32
    v_exp_f32 v33, v33
    s_waitcnt lgkmcnt(1)
    v_smfmac_f32_32x32x32_bf16 v[212:227], v[96:99], v[24:31], v100
    v_exp_f32 v34, v34
    v_exp_f32 v35, v35
    v_exp_f32 v36, v36
    s_waitcnt lgkmcnt(0)
    v_mfma_f32_32x32x16_bf16 v[16:31], v[88:91], v[80:83], 0
    v_exp_f32 v37, v37
    v_exp_f32 v38, v38
    v_exp_f32 v39, v39
    v_exp_f32 v40, v40
    v_exp_f32 v41, v41
    v_smfmac_f32_32x32x32_bf16 v[228:243], v[92:95], v[32:39], v100
    ds_read_b128 v[92:95], v245 offset:24608
    v_exp_f32 v42, v42
    v_exp_f32 v43, v43
    v_exp_f32 v44, v44
    v_exp_f32 v45, v45
    v_exp_f32 v46, v46
    v_exp_f32 v47, v47
    s_mul_i32 s15, s3, 10240
    s_add_u32 m0, s15, 75264
    s_nop 0
    buffer_load_dwordx4 v9, s[60:63], s82 offen lds
    s_setprio 0
    v_exp_f32 v16, v16
    v_exp_f32 v17, v17
    v_smfmac_f32_32x32x32_bf16 v[228:243], v[96:99], v[40:47], v100
    ds_read_b128 v[96:99], v246 offset:24608
    v_exp_f32 v18, v18
    v_exp_f32 v19, v19
    v_exp_f32 v20, v20
    v_mfma_f32_32x32x16_bf16 v[32:47], v[88:91], v[84:87], 0
    ds_read_b128 v[88:91], v244 offset:26672
    v_exp_f32 v21, v21
    v_exp_f32 v22, v22
    v_exp_f32 v23, v23
    v_exp_f32 v24, v24
    v_exp_f32 v25, v25
    s_waitcnt lgkmcnt(2)
    v_smfmac_f32_32x32x32_bf16 v[212:227], v[92:95], v[16:23], v100
    s_setprio 1
    v_exp_f32 v26, v26
    v_exp_f32 v27, v27
    v_exp_f32 v28, v28
    v_exp_f32 v29, v29
    v_exp_f32 v30, v30
    v_exp_f32 v31, v31
    v_exp_f32 v32, v32
    v_exp_f32 v33, v33
    s_waitcnt lgkmcnt(1)
    v_smfmac_f32_32x32x32_bf16 v[212:227], v[96:99], v[24:31], v100
    v_exp_f32 v34, v34
    v_exp_f32 v35, v35
    v_exp_f32 v36, v36
    s_waitcnt lgkmcnt(0)
    v_mfma_f32_32x32x16_bf16 v[16:31], v[88:91], v[80:83], 0
    v_exp_f32 v37, v37
    v_exp_f32 v38, v38
    v_exp_f32 v39, v39
    v_exp_f32 v40, v40
    v_exp_f32 v41, v41
    v_smfmac_f32_32x32x32_bf16 v[228:243], v[92:95], v[32:39], v100
    ds_read_b128 v[92:95], v245 offset:26672
    v_exp_f32 v42, v42
    v_exp_f32 v43, v43
    v_exp_f32 v44, v44
    v_exp_f32 v45, v45
    v_exp_f32 v46, v46
    v_exp_f32 v47, v47
    s_setprio 0
    v_exp_f32 v16, v16
    v_exp_f32 v17, v17
    v_smfmac_f32_32x32x32_bf16 v[228:243], v[96:99], v[40:47], v100
    ds_read_b128 v[96:99], v246 offset:26672
    v_exp_f32 v18, v18
    v_exp_f32 v19, v19
    v_exp_f32 v20, v20
    v_mfma_f32_32x32x16_bf16 v[32:47], v[88:91], v[84:87], 0
    v_add_u32 v244, 40960, v244
    ds_read_b128 v[88:91], v244 offset:0
    v_exp_f32 v21, v21
    v_exp_f32 v22, v22
    v_exp_f32 v23, v23
    v_exp_f32 v24, v24
    v_exp_f32 v25, v25
    s_waitcnt lgkmcnt(2)
    v_smfmac_f32_32x32x32_bf16 v[212:227], v[92:95], v[16:23], v100
    s_setprio 1
    v_exp_f32 v26, v26
    v_exp_f32 v27, v27
    v_exp_f32 v28, v28
    v_exp_f32 v29, v29
    v_exp_f32 v30, v30
    v_exp_f32 v31, v31
    v_exp_f32 v32, v32
    v_exp_f32 v33, v33
    s_waitcnt lgkmcnt(1)
    v_smfmac_f32_32x32x32_bf16 v[212:227], v[96:99], v[24:31], v100
    v_exp_f32 v34, v34
    v_exp_f32 v35, v35
    v_exp_f32 v36, v36
    s_waitcnt lgkmcnt(0)
    v_mfma_f32_32x32x16_bf16 v[16:31], v[88:91], v[80:83], 0
    v_exp_f32 v37, v37
    v_exp_f32 v38, v38
    v_exp_f32 v39, v39
    v_exp_f32 v40, v40
    v_exp_f32 v41, v41
    v_smfmac_f32_32x32x32_bf16 v[228:243], v[92:95], v[32:39], v100
    v_add_u32 v245, 40960, v245
    ds_read_b128 v[92:95], v245 offset:0
    v_exp_f32 v42, v42
    v_exp_f32 v43, v43
    v_exp_f32 v44, v44
    v_exp_f32 v45, v45
    v_exp_f32 v46, v46
    v_exp_f32 v47, v47
    s_setprio 0
    v_exp_f32 v16, v16
    v_exp_f32 v17, v17
    v_smfmac_f32_32x32x32_bf16 v[228:243], v[96:99], v[40:47], v100
    v_add_u32 v246, 40960, v246
    ds_read_b128 v[96:99], v246 offset:0
    v_exp_f32 v18, v18
    v_exp_f32 v19, v19
    v_exp_f32 v20, v20
    v_mfma_f32_32x32x16_bf16 v[32:47], v[88:91], v[84:87], 0
    ds_read_b128 v[88:91], v244 offset:2064
    v_exp_f32 v21, v21
    v_exp_f32 v22, v22
    v_exp_f32 v23, v23
    v_exp_f32 v24, v24
    v_exp_f32 v25, v25
    s_waitcnt lgkmcnt(2)
    v_smfmac_f32_32x32x32_bf16 v[212:227], v[92:95], v[16:23], v100
    s_setprio 1
    v_exp_f32 v26, v26
    v_exp_f32 v27, v27
    v_exp_f32 v28, v28
    v_exp_f32 v29, v29
    v_exp_f32 v30, v30
    v_exp_f32 v31, v31
    v_exp_f32 v32, v32
    v_exp_f32 v33, v33
    s_waitcnt lgkmcnt(1)
    v_smfmac_f32_32x32x32_bf16 v[212:227], v[96:99], v[24:31], v100
    v_exp_f32 v34, v34
    v_exp_f32 v35, v35
    v_exp_f32 v36, v36
    s_waitcnt lgkmcnt(0)
    v_mfma_f32_32x32x16_bf16 v[16:31], v[88:91], v[80:83], 0
    v_exp_f32 v37, v37
    v_exp_f32 v38, v38
    s_waitcnt vmcnt(0)
    ds_read_b64_tr_b16 v[128:129], v7 offset:9216
    ds_read_b64_tr_b16 v[130:131], v7 offset:9728
    v_exp_f32 v39, v39
    v_exp_f32 v40, v40
    v_exp_f32 v41, v41
    v_smfmac_f32_32x32x32_bf16 v[228:243], v[92:95], v[32:39], v100
    ds_read_b128 v[92:95], v245 offset:2064
    v_exp_f32 v42, v42
    v_exp_f32 v43, v43
    v_exp_f32 v44, v44
    v_exp_f32 v45, v45
    v_exp_f32 v46, v46
    s_waitcnt lgkmcnt(1)
    buffer_store_dwordx4 v[128:131], v5, s[56:59], s79 offen sc1
    v_exp_f32 v47, v47
    s_setprio 0
    v_exp_f32 v16, v16
    v_exp_f32 v17, v17
    v_smfmac_f32_32x32x32_bf16 v[228:243], v[96:99], v[40:47], v100
    ds_read_b128 v[96:99], v246 offset:2064
    v_exp_f32 v18, v18
    v_exp_f32 v19, v19
    v_exp_f32 v20, v20
    v_mfma_f32_32x32x16_bf16 v[32:47], v[88:91], v[84:87], 0
    ds_read_b128 v[88:91], v244 offset:4128
    v_exp_f32 v21, v21
    v_exp_f32 v22, v22
    v_exp_f32 v23, v23
    v_exp_f32 v24, v24
    v_exp_f32 v25, v25
    s_waitcnt lgkmcnt(2)
    v_smfmac_f32_32x32x32_bf16 v[212:227], v[92:95], v[16:23], v100
    s_setprio 1
    v_exp_f32 v26, v26
    v_exp_f32 v27, v27
    v_exp_f32 v28, v28
    s_mul_i32 s14, s5, 180224
    s_add_u32 s14, s14, 10485760
    s_add_u32 s52, s40, s14
    s_addc_u32 s53, s41, 0
    s_mov_b32 s54, 176128
    s_mov_b32 s55, 0x00020000
    s_lshl_b32 s14, s5, 16
    s_add_u32 s14, s14, 12582912
    s_add_u32 s60, s40, s14
    s_addc_u32 s61, s41, 0
    s_mov_b32 s62, 65536
    s_mov_b32 s63, 0x00020000
    s_lshl_b32 s14, s4, 16
    s_add_u32 s14, s14, 13631488
    s_add_u32 s64, s40, s14
    s_addc_u32 s65, s41, 0
    s_mov_b32 s66, 65536
    s_mov_b32 s67, 0x00020000
    s_mov_b32 s80, s34
    s_mov_b32 s81, s35
    s_mov_b32 s82, 1024
    s_mov_b32 s83, 0x00020000
    s_mov_b32 s76, s36
    s_mov_b32 s77, s37
    s_mov_b32 s78, 2097152
    s_mov_b32 s79, 0x00020000
    v_exp_f32 v29, v29
    v_exp_f32 v30, v30
    v_exp_f32 v31, v31
    v_exp_f32 v32, v32
    v_exp_f32 v33, v33
    s_waitcnt lgkmcnt(1)
    v_smfmac_f32_32x32x32_bf16 v[212:227], v[96:99], v[24:31], v100
    v_exp_f32 v34, v34
    v_exp_f32 v35, v35
    v_exp_f32 v36, v36
    s_waitcnt lgkmcnt(0)
    v_mfma_f32_32x32x16_bf16 v[16:31], v[88:91], v[80:83], 0
    v_exp_f32 v37, v37
    v_exp_f32 v38, v38
    v_exp_f32 v39, v39
    v_exp_f32 v40, v40
    v_exp_f32 v41, v41
    v_smfmac_f32_32x32x32_bf16 v[228:243], v[92:95], v[32:39], v100
    ds_read_b128 v[92:95], v245 offset:4128
    v_exp_f32 v42, v42
    v_exp_f32 v43, v43
    v_exp_f32 v44, v44
    s_lshl_b32 s8, s3, 11
    s_lshr_b32 s73, s3, 1
    s_lshl_b32 s73, s73, 14
    s_and_b32 s11, s3, 1
    s_lshl_b32 s11, s11, 10
    s_add_u32 s11, s11, s73
    s_lshl_b32 s12, s4, 16
    s_lshl_b32 s13, s3, 13
    s_add_u32 s12, s12, s13
    s_lshl_b32 s13, s5, 7
    s_add_u32 s12, s12, s13
    v_exp_f32 v45, v45
    v_exp_f32 v46, v46
    v_exp_f32 v47, v47
    s_waitcnt vmcnt(0) lgkmcnt(0)
    s_barrier
    s_cmp_lg_u32 s3, 0
    s_cbranch_scc1 L_noflag2
    s_lshl_b32 s14, s4, 3
    s_add_u32 s14, s14, s5
    s_lshl_b32 s14, s14, 7
    s_add_u32 s14, s14, 163840
    v_mov_b32 v101, s84
    s_mov_b64 exec, 1
    buffer_store_dword v101, v5, s[56:59], s14 offen sc1
    s_mov_b64 exec, -1
L_noflag2:
    s_setprio 0
    v_exp_f32 v16, v16
    v_exp_f32 v17, v17
    v_smfmac_f32_32x32x32_bf16 v[228:243], v[96:99], v[40:47], v100
    ds_read_b128 v[96:99], v246 offset:4128
    v_exp_f32 v18, v18
    v_exp_f32 v19, v19
    v_exp_f32 v20, v20
    v_mfma_f32_32x32x16_bf16 v[32:47], v[88:91], v[84:87], 0
    ds_read_b128 v[88:91], v244 offset:6192
    v_exp_f32 v21, v21
    v_exp_f32 v22, v22
    v_exp_f32 v23, v23
    v_exp_f32 v24, v24
    v_exp_f32 v25, v25
    v_smfmac_f32_32x32x32_bf16 v[212:227], v[92:95], v[16:23], v100
    s_setprio 1
    v_exp_f32 v26, v26
    v_exp_f32 v27, v27
    v_exp_f32 v28, v28
    v_exp_f32 v29, v29
    v_exp_f32 v30, v30
    v_exp_f32 v31, v31
    v_exp_f32 v32, v32
    v_exp_f32 v33, v33
    s_waitcnt lgkmcnt(1)
    v_smfmac_f32_32x32x32_bf16 v[212:227], v[96:99], v[24:31], v100
    v_exp_f32 v34, v34
    v_exp_f32 v35, v35
    v_exp_f32 v36, v36
    s_waitcnt lgkmcnt(0)
    v_mfma_f32_32x32x16_bf16 v[16:31], v[88:91], v[80:83], 0
    v_exp_f32 v37, v37
    v_exp_f32 v38, v38
    v_exp_f32 v39, v39
    v_exp_f32 v40, v40
    v_exp_f32 v41, v41
    v_smfmac_f32_32x32x32_bf16 v[228:243], v[92:95], v[32:39], v100
    ds_read_b128 v[92:95], v245 offset:6192
    v_exp_f32 v42, v42
    v_exp_f32 v43, v43
    v_exp_f32 v44, v44
    s_mul_i32 s14, s3, 2304
    s_add_u32 s14, s14, 131584
    s_xor_b32 s15, s3, 4
    s_mul_i32 s15, s15, 2304
    s_add_u32 s15, s15, 131584
    v_add_u32 v1, s14, v5
    v_lshl_add_u32 v2, v0, 2, s14
    v_add_u32 v3, s15, v5
    v_lshl_add_u32 v4, v0, 2, s15
    v_exp_f32 v45, v45
    v_exp_f32 v46, v46
    v_exp_f32 v47, v47
    s_setprio 0
    v_exp_f32 v16, v16
    v_exp_f32 v17, v17
    v_smfmac_f32_32x32x32_bf16 v[228:243], v[96:99], v[40:47], v100
    ds_read_b128 v[96:99], v246 offset:6192
    v_exp_f32 v18, v18
    v_exp_f32 v19, v19
    v_exp_f32 v20, v20
    v_mfma_f32_32x32x16_bf16 v[32:47], v[88:91], v[84:87], 0
    ds_read_b128 v[88:91], v244 offset:20480
    v_exp_f32 v21, v21
    v_exp_f32 v22, v22
    v_exp_f32 v23, v23
    v_exp_f32 v24, v24
    v_exp_f32 v25, v25
    s_waitcnt lgkmcnt(2)
    v_smfmac_f32_32x32x32_bf16 v[212:227], v[92:95], v[16:23], v100
    s_setprio 1
    v_exp_f32 v26, v26
    v_exp_f32 v27, v27
    v_exp_f32 v28, v28
    v_exp_f32 v29, v29
    v_exp_f32 v30, v30
    v_exp_f32 v31, v31
    v_exp_f32 v32, v32
    v_exp_f32 v33, v33
    s_waitcnt lgkmcnt(1)
    v_smfmac_f32_32x32x32_bf16 v[212:227], v[96:99], v[24:31], v100
    v_exp_f32 v34, v34
    v_exp_f32 v35, v35
    v_exp_f32 v36, v36
    s_waitcnt lgkmcnt(0)
    v_mfma_f32_32x32x16_bf16 v[16:31], v[88:91], v[80:83], 0
    v_exp_f32 v37, v37
    v_exp_f32 v38, v38
    v_exp_f32 v39, v39
    v_exp_f32 v40, v40
    v_exp_f32 v41, v41
    v_smfmac_f32_32x32x32_bf16 v[228:243], v[92:95], v[32:39], v100
    ds_read_b128 v[92:95], v245 offset:20480
    v_exp_f32 v42, v42
    v_exp_f32 v43, v43
    v_exp_f32 v44, v44
    v_exp_f32 v45, v45
    v_exp_f32 v46, v46
    v_exp_f32 v47, v47
    s_setprio 0
    v_exp_f32 v16, v16
    v_exp_f32 v17, v17
    v_smfmac_f32_32x32x32_bf16 v[228:243], v[96:99], v[40:47], v100
    ds_read_b128 v[96:99], v246 offset:20480
    v_exp_f32 v18, v18
    v_exp_f32 v19, v19
    v_exp_f32 v20, v20
    v_mfma_f32_32x32x16_bf16 v[32:47], v[88:91], v[84:87], 0
    ds_read_b128 v[88:91], v244 offset:22544
    v_exp_f32 v21, v21
    v_exp_f32 v22, v22
    v_exp_f32 v23, v23
    v_exp_f32 v24, v24
    v_exp_f32 v25, v25
    s_waitcnt lgkmcnt(2)
    v_smfmac_f32_32x32x32_bf16 v[212:227], v[92:95], v[16:23], v100
    s_setprio 1
    v_exp_f32 v26, v26
    v_exp_f32 v27, v27
    v_exp_f32 v28, v28
    s_mov_b32 s85, 163840
    buffer_load_dword v102, v248, s[56:59], s85 offen sc1
    v_exp_f32 v29, v29
    v_exp_f32 v30, v30
    v_exp_f32 v31, v31
    v_exp_f32 v32, v32
    v_exp_f32 v33, v33
    s_waitcnt lgkmcnt(1)
    v_smfmac_f32_32x32x32_bf16 v[212:227], v[96:99], v[24:31], v100
    v_exp_f32 v34, v34
    v_exp_f32 v35, v35
    v_exp_f32 v36, v36
    s_waitcnt lgkmcnt(0)
    v_mfma_f32_32x32x16_bf16 v[16:31], v[88:91], v[80:83], 0
    v_exp_f32 v37, v37
    v_exp_f32 v38, v38
    v_exp_f32 v39, v39
    v_exp_f32 v40, v40
    v_exp_f32 v41, v41
    v_smfmac_f32_32x32x32_bf16 v[228:243], v[92:95], v[32:39], v100
    ds_read_b128 v[92:95], v245 offset:22544
    v_exp_f32 v42, v42
    v_exp_f32 v43, v43
    v_exp_f32 v44, v44
    v_exp_f32 v45, v45
    v_exp_f32 v46, v46
    v_exp_f32 v47, v47
    s_setprio 0
    v_exp_f32 v16, v16
    v_exp_f32 v17, v17
    v_smfmac_f32_32x32x32_bf16 v[228:243], v[96:99], v[40:47], v100
    ds_read_b128 v[96:99], v246 offset:22544
    v_exp_f32 v18, v18
    v_exp_f32 v19, v19
    v_exp_f32 v20, v20
    v_mfma_f32_32x32x16_bf16 v[32:47], v[88:91], v[84:87], 0
    ds_read_b128 v[88:91], v244 offset:24608
    v_exp_f32 v21, v21
    v_exp_f32 v22, v22
    v_and_b32 v101, 0x70, v251
    buffer_load_dwordx4 v[200:203], v251, s[44:47], s12 offen
    buffer_load_dwordx4 v[204:207], v101, s[80:83], s13 offen
    v_exp_f32 v23, v23
    v_exp_f32 v24, v24
    v_exp_f32 v25, v25
    s_waitcnt lgkmcnt(2)
    v_smfmac_f32_32x32x32_bf16 v[212:227], v[92:95], v[16:23], v100
    s_setprio 1
    v_exp_f32 v26, v26
    v_exp_f32 v27, v27
    v_exp_f32 v28, v28
    v_exp_f32 v29, v29
    v_exp_f32 v30, v30
    s_waitcnt vmcnt(2)
    v_cmp_eq_u32 vcc, s84, v102
    s_nop 1
    s_cmp_eq_u64 vcc, exec
    s_cbranch_scc0 L_spin2
L_spin2_ret:
    v_exp_f32 v31, v31
    v_exp_f32 v32, v32
    v_exp_f32 v33, v33
    s_waitcnt lgkmcnt(1)
    v_smfmac_f32_32x32x32_bf16 v[212:227], v[96:99], v[24:31], v100
    v_exp_f32 v34, v34
    v_exp_f32 v35, v35
    v_exp_f32 v36, v36
    s_waitcnt lgkmcnt(0)
    v_mfma_f32_32x32x16_bf16 v[16:31], v[88:91], v[80:83], 0
    v_exp_f32 v37, v37
    v_exp_f32 v38, v38
    buffer_load_dwordx4 v[168:171], v5, s[52:55], s8 offen offset:0 sc1
    v_exp_f32 v39, v39
    v_exp_f32 v40, v40
    v_exp_f32 v41, v41
    v_smfmac_f32_32x32x32_bf16 v[228:243], v[92:95], v[32:39], v100
    ds_read_b128 v[92:95], v245 offset:24608
    v_exp_f32 v42, v42
    v_exp_f32 v43, v43
    v_exp_f32 v44, v44
    v_exp_f32 v45, v45
    v_exp_f32 v46, v46
    buffer_load_dwordx4 v[172:175], v5, s[68:71], s8 offen offset:0 sc1
    v_exp_f32 v47, v47
    s_setprio 0
    v_exp_f32 v16, v16
    v_exp_f32 v17, v17
    v_smfmac_f32_32x32x32_bf16 v[228:243], v[96:99], v[40:47], v100
    ds_read_b128 v[96:99], v246 offset:24608
    v_exp_f32 v18, v18
    v_exp_f32 v19, v19
    v_exp_f32 v20, v20
    v_mfma_f32_32x32x16_bf16 v[32:47], v[88:91], v[84:87], 0
    ds_read_b128 v[88:91], v244 offset:26672
    v_exp_f32 v21, v21
    v_exp_f32 v22, v22
    buffer_load_dwordx4 v[176:179], v5, s[68:71], s8 offen offset:1024 sc1
    v_exp_f32 v23, v23
    v_exp_f32 v24, v24
    v_exp_f32 v25, v25
    s_waitcnt lgkmcnt(2)
    v_smfmac_f32_32x32x32_bf16 v[212:227], v[92:95], v[16:23], v100
    s_setprio 1
    v_exp_f32 v26, v26
    v_exp_f32 v27, v27
    v_exp_f32 v28, v28
    v_exp_f32 v29, v29
    v_exp_f32 v30, v30
    v_exp_f32 v31, v31
    v_exp_f32 v32, v32
    v_exp_f32 v33, v33
    s_waitcnt lgkmcnt(1)
    v_smfmac_f32_32x32x32_bf16 v[212:227], v[96:99], v[24:31], v100
    v_exp_f32 v34, v34
    v_exp_f32 v35, v35
    v_exp_f32 v36, v36
    s_waitcnt lgkmcnt(0)
    v_mfma_f32_32x32x16_bf16 v[16:31], v[88:91], v[80:83], 0
    v_exp_f32 v37, v37
    v_exp_f32 v38, v38
    buffer_load_dwordx4 v[180:183], v5, s[52:55], s8 offen offset:1024 sc1
    s_add_u32 s8, s8, 16384
    v_exp_f32 v39, v39
    v_exp_f32 v40, v40
    v_exp_f32 v41, v41
    v_smfmac_f32_32x32x32_bf16 v[228:243], v[92:95], v[32:39], v100
    ds_read_b128 v[92:95], v245 offset:26672
    v_exp_f32 v42, v42
    v_exp_f32 v43, v43
    v_exp_f32 v44, v44
    v_exp_f32 v45, v45
    v_exp_f32 v46, v46
    buffer_load_dwordx4 v[184:187], v5, s[52:55], s8 offen offset:0 sc1
    v_exp_f32 v47, v47
    s_setprio 0
    v_exp_f32 v16, v16
    v_exp_f32 v17, v17
    v_smfmac_f32_32x32x32_bf16 v[228:243], v[96:99], v[40:47], v100
    ds_read_b128 v[96:99], v246 offset:26672
    v_exp_f32 v18, v18
    v_exp_f32 v19, v19
    v_exp_f32 v20, v20
    v_mfma_f32_32x32x16_bf16 v[32:47], v[88:91], v[84:87], 0
    v_subrev_u32 v244, s87, v244
    ds_read_b128 v[88:91], v244 offset:0
    v_exp_f32 v21, v21
    v_exp_f32 v22, v22
    v_exp_f32 v23, v23
    v_exp_f32 v24, v24
    v_exp_f32 v25, v25
    s_waitcnt lgkmcnt(2)
    v_smfmac_f32_32x32x32_bf16 v[212:227], v[92:95], v[16:23], v100
    s_setprio 1
    v_exp_f32 v26, v26
    v_exp_f32 v27, v27
    v_exp_f32 v28, v28
    v_exp_f32 v29, v29
    v_exp_f32 v30, v30
    buffer_load_dwordx4 v[188:191], v5, s[68:71], s8 offen offset:0 sc1
    v_exp_f32 v31, v31
    s_waitcnt vmcnt(4)
    v_mfma_f32_32x32x16_bf16 v[104:119], v[168:171], v[172:175], 0
    v_exp_f32 v32, v32
    v_exp_f32 v33, v33
    s_waitcnt lgkmcnt(1)
    v_smfmac_f32_32x32x32_bf16 v[212:227], v[96:99], v[24:31], v100
    v_exp_f32 v34, v34
    v_exp_f32 v35, v35
    v_exp_f32 v36, v36
    s_waitcnt lgkmcnt(0)
    v_mfma_f32_32x32x16_bf16 v[16:31], v[88:91], v[80:83], 0
    v_exp_f32 v37, v37
    v_exp_f32 v38, v38
    buffer_load_dwordx4 v[192:195], v5, s[68:71], s8 offen offset:1024 sc1
    v_exp_f32 v39, v39
    v_exp_f32 v40, v40
    v_exp_f32 v41, v41
    v_smfmac_f32_32x32x32_bf16 v[228:243], v[92:95], v[32:39], v100
    v_subrev_u32 v245, s87, v245
    ds_read_b128 v[92:95], v245 offset:0
    v_exp_f32 v42, v42
    v_exp_f32 v43, v43
    v_exp_f32 v44, v44
    s_waitcnt vmcnt(4)
    v_mfma_f32_32x32x16_bf16 v[120:135], v[168:171], v[176:179], 0
    v_exp_f32 v45, v45
    v_exp_f32 v46, v46
    v_exp_f32 v47, v47
    s_setprio 0
    v_exp_f32 v16, v16
    v_exp_f32 v17, v17
    v_smfmac_f32_32x32x32_bf16 v[228:243], v[96:99], v[40:47], v100
    v_subrev_u32 v246, s87, v246
    ds_read_b128 v[96:99], v246 offset:0
    v_exp_f32 v18, v18
    v_exp_f32 v19, v19
    v_exp_f32 v20, v20
    v_mfma_f32_32x32x16_bf16 v[32:47], v[88:91], v[84:87], 0
    ds_read_b128 v[88:91], v244 offset:2064
    v_exp_f32 v21, v21
    v_exp_f32 v22, v22
    buffer_load_dwordx4 v[196:199], v5, s[52:55], s8 offen offset:1024 sc1
    s_add_u32 s8, s8, 16384
    v_exp_f32 v23, v23
    v_exp_f32 v24, v24
    v_exp_f32 v25, v25
    s_waitcnt lgkmcnt(2)
    v_smfmac_f32_32x32x32_bf16 v[212:227], v[92:95], v[16:23], v100
    s_setprio 1
    v_exp_f32 v26, v26
    v_exp_f32 v27, v27
    v_exp_f32 v28, v28
    s_waitcnt vmcnt(4)
    v_mfma_f32_32x32x16_bf16 v[136:151], v[180:183], v[172:175], 0
    v_exp_f32 v29, v29
    v_exp_f32 v30, v30
    buffer_load_dwordx4 v[168:171], v5, s[52:55], s8 offen offset:0 sc1
    v_exp_f32 v31, v31
    v_mfma_f32_32x32x16_bf16 v[152:167], v[180:183], v[176:179], 0
    v_exp_f32 v32, v32
    v_exp_f32 v33, v33
    s_waitcnt lgkmcnt(1)
    v_smfmac_f32_32x32x32_bf16 v[212:227], v[96:99], v[24:31], v100
    v_exp_f32 v34, v34
    v_exp_f32 v35, v35
    v_exp_f32 v36, v36
    s_waitcnt lgkmcnt(0)
    v_mfma_f32_32x32x16_bf16 v[16:31], v[88:91], v[80:83], 0
    v_exp_f32 v37, v37
    v_exp_f32 v38, v38
    v_exp_f32 v39, v39
    v_exp_f32 v40, v40
    v_exp_f32 v41, v41
    v_smfmac_f32_32x32x32_bf16 v[228:243], v[92:95], v[32:39], v100
    ds_read_b128 v[92:95], v245 offset:2064
    v_exp_f32 v42, v42
    v_exp_f32 v43, v43
    v_exp_f32 v44, v44
    v_exp_f32 v45, v45
    v_exp_f32 v46, v46
    buffer_load_dwordx4 v[172:175], v5, s[68:71], s8 offen offset:0 sc1
    v_exp_f32 v47, v47
    s_waitcnt vmcnt(4)
    v_mfma_f32_32x32x16_bf16 v[104:119], v[184:187], v[188:191], v[104:119]
    s_barrier
    s_setprio 0
    v_exp_f32 v16, v16
    v_exp_f32 v17, v17
    v_smfmac_f32_32x32x32_bf16 v[228:243], v[96:99], v[40:47], v100
    ds_read_b128 v[96:99], v246 offset:2064
    v_exp_f32 v18, v18
    v_exp_f32 v19, v19
    v_exp_f32 v20, v20
    v_mfma_f32_32x32x16_bf16 v[32:47], v[88:91], v[84:87], 0
    ds_read_b128 v[88:91], v244 offset:4128
    v_exp_f32 v21, v21
    v_exp_f32 v22, v22
    buffer_load_dwordx4 v[176:179], v5, s[68:71], s8 offen offset:1024 sc1
    v_exp_f32 v23, v23
    v_exp_f32 v24, v24
    v_exp_f32 v25, v25
    s_waitcnt lgkmcnt(2)
    v_smfmac_f32_32x32x32_bf16 v[212:227], v[92:95], v[16:23], v100
    s_setprio 1
    v_exp_f32 v26, v26
    v_exp_f32 v27, v27
    v_exp_f32 v28, v28
    s_waitcnt vmcnt(4)
    v_mfma_f32_32x32x16_bf16 v[120:135], v[184:187], v[192:195], v[120:135]
    v_exp_f32 v29, v29
    v_exp_f32 v30, v30
    v_exp_f32 v31, v31
    v_exp_f32 v32, v32
    v_exp_f32 v33, v33
    s_waitcnt lgkmcnt(1)
    v_smfmac_f32_32x32x32_bf16 v[212:227], v[96:99], v[24:31], v100
    v_exp_f32 v34, v34
    v_exp_f32 v35, v35
    v_exp_f32 v36, v36
    s_waitcnt lgkmcnt(0)
    v_mfma_f32_32x32x16_bf16 v[16:31], v[88:91], v[80:83], 0
    v_exp_f32 v37, v37
    v_exp_f32 v38, v38
    buffer_load_dwordx4 v[180:183], v5, s[52:55], s8 offen offset:1024 sc1
    s_add_u32 s8, s8, 16384
    v_exp_f32 v39, v39
    v_exp_f32 v40, v40
    v_exp_f32 v41, v41
    v_smfmac_f32_32x32x32_bf16 v[228:243], v[92:95], v[32:39], v100
    ds_read_b128 v[92:95], v245 offset:4128
    v_exp_f32 v42, v42
    v_exp_f32 v43, v43
    v_exp_f32 v44, v44
    s_waitcnt vmcnt(4)
    v_mfma_f32_32x32x16_bf16 v[136:151], v[196:199], v[188:191], v[136:151]
    v_exp_f32 v45, v45
    v_exp_f32 v46, v46
    buffer_load_dwordx4 v[184:187], v5, s[52:55], s8 offen offset:0 sc1
    v_exp_f32 v47, v47
    v_mfma_f32_32x32x16_bf16 v[152:167], v[196:199], v[192:195], v[152:167]
    s_setprio 0
    v_exp_f32 v16, v16
    v_exp_f32 v17, v17
    v_smfmac_f32_32x32x32_bf16 v[228:243], v[96:99], v[40:47], v100
    ds_read_b128 v[96:99], v246 offset:4128
    v_exp_f32 v18, v18
    v_exp_f32 v19, v19
    v_exp_f32 v20, v20
    v_mfma_f32_32x32x16_bf16 v[32:47], v[88:91], v[84:87], 0
    ds_read_b128 v[88:91], v244 offset:6192
    v_exp_f32 v21, v21
    v_exp_f32 v22, v22
    v_exp_f32 v23, v23
    v_exp_f32 v24, v24
    v_exp_f32 v25, v25
    s_waitcnt lgkmcnt(2)
    v_smfmac_f32_32x32x32_bf16 v[212:227], v[92:95], v[16:23], v100
    s_setprio 1
    v_exp_f32 v26, v26
    v_exp_f32 v27, v27
    v_exp_f32 v28, v28
    v_exp_f32 v29, v29
    v_exp_f32 v30, v30
    buffer_load_dwordx4 v[188:191], v5, s[68:71], s8 offen offset:0 sc1
    s_lshl_b32 s10, s3, 13
    s_add_u32 m0, s10, 66048
    s_nop 0
    buffer_load_dwordx4 v5, s[60:63], s10 offen offset:0 sc1 lds
    v_exp_f32 v31, v31
    s_waitcnt vmcnt(5)
    v_mfma_f32_32x32x16_bf16 v[104:119], v[168:171], v[172:175], v[104:119]
    v_exp_f32 v32, v32
    v_exp_f32 v33, v33
    s_waitcnt lgkmcnt(1)
    v_smfmac_f32_32x32x32_bf16 v[212:227], v[96:99], v[24:31], v100
    v_exp_f32 v34, v34
    v_exp_f32 v35, v35
    v_exp_f32 v36, v36
    s_waitcnt lgkmcnt(0)
    v_mfma_f32_32x32x16_bf16 v[16:31], v[88:91], v[80:83], 0
    v_exp_f32 v37, v37
    v_exp_f32 v38, v38
    buffer_load_dwordx4 v[192:195], v5, s[68:71], s8 offen offset:1024 sc1
    v_exp_f32 v39, v39
    v_exp_f32 v40, v40
    v_exp_f32 v41, v41
    v_smfmac_f32_32x32x32_bf16 v[228:243], v[92:95], v[32:39], v100
    ds_read_b128 v[92:95], v245 offset:6192
    v_exp_f32 v42, v42
    v_exp_f32 v43, v43
    v_exp_f32 v44, v44
    s_waitcnt vmcnt(5)
    v_mfma_f32_32x32x16_bf16 v[120:135], v[168:171], v[176:179], v[120:135]
    v_exp_f32 v45, v45
    v_exp_f32 v46, v46
    v_exp_f32 v47, v47
    s_setprio 0
    v_exp_f32 v16, v16
    v_exp_f32 v17, v17
    v_smfmac_f32_32x32x32_bf16 v[228:243], v[96:99], v[40:47], v100
    ds_read_b128 v[96:99], v246 offset:6192
    v_exp_f32 v18, v18
    v_exp_f32 v19, v19
    v_exp_f32 v20, v20
    v_mfma_f32_32x32x16_bf16 v[32:47], v[88:91], v[84:87], 0
    ds_read_b128 v[88:91], v244 offset:8256
    v_exp_f32 v21, v21
    v_exp_f32 v22, v22
    buffer_load_dwordx4 v[196:199], v5, s[52:55], s8 offen offset:1024 sc1
    s_add_u32 s8, s8, 16384
    v_exp_f32 v23, v23
    v_exp_f32 v24, v24
    v_exp_f32 v25, v25
    s_waitcnt lgkmcnt(2)
    v_smfmac_f32_32x32x32_bf16 v[212:227], v[92:95], v[16:23], v100
    s_setprio 1
    v_exp_f32 v26, v26
    v_exp_f32 v27, v27
    v_exp_f32 v28, v28
    s_waitcnt vmcnt(5)
    v_mfma_f32_32x32x16_bf16 v[136:151], v[180:183], v[172:175], v[136:151]
    v_exp_f32 v29, v29
    v_exp_f32 v30, v30
    buffer_load_dwordx4 v[168:171], v5, s[52:55], s8 offen offset:0 sc1
    v_exp_f32 v31, v31
    v_mfma_f32_32x32x16_bf16 v[152:167], v[180:183], v[176:179], v[152:167]
    v_exp_f32 v32, v32
    v_exp_f32 v33, v33
    s_waitcnt lgkmcnt(1)
    v_smfmac_f32_32x32x32_bf16 v[212:227], v[96:99], v[24:31], v100
    v_exp_f32 v34, v34
    v_exp_f32 v35, v35
    v_exp_f32 v36, v36
    s_waitcnt lgkmcnt(0)
    v_mfma_f32_32x32x16_bf16 v[16:31], v[88:91], v[80:83], 0
    v_exp_f32 v37, v37
    v_exp_f32 v38, v38
    v_exp_f32 v39, v39
    v_exp_f32 v40, v40
    v_exp_f32 v41, v41
    v_smfmac_f32_32x32x32_bf16 v[228:243], v[92:95], v[32:39], v100
    ds_read_b128 v[92:95], v245 offset:8256
    v_exp_f32 v42, v42
    v_exp_f32 v43, v43
    v_exp_f32 v44, v44
    v_exp_f32 v45, v45
    v_exp_f32 v46, v46
    buffer_load_dwordx4 v[172:175], v5, s[68:71], s8 offen offset:0 sc1
    buffer_load_dwordx4 v5, s[60:63], s10 offen offset:1024 sc1 lds
    v_exp_f32 v47, v47
    s_waitcnt vmcnt(6)
    v_mfma_f32_32x32x16_bf16 v[104:119], v[184:187], v[188:191], v[104:119]
    s_setprio 0
    v_exp_f32 v16, v16
    v_exp_f32 v17, v17
    v_smfmac_f32_32x32x32_bf16 v[228:243], v[96:99], v[40:47], v100
    ds_read_b128 v[96:99], v246 offset:8256
    v_exp_f32 v18, v18
    v_exp_f32 v19, v19
    v_exp_f32 v20, v20
    v_mfma_f32_32x32x16_bf16 v[32:47], v[88:91], v[84:87], 0
    ds_read_b128 v[88:91], v244 offset:10320
    v_exp_f32 v21, v21
    v_exp_f32 v22, v22
    buffer_load_dwordx4 v[176:179], v5, s[68:71], s8 offen offset:1024 sc1
    v_exp_f32 v23, v23
    v_exp_f32 v24, v24
    v_exp_f32 v25, v25
    s_waitcnt lgkmcnt(2)
    v_smfmac_f32_32x32x32_bf16 v[212:227], v[92:95], v[16:23], v100
    s_setprio 1
    v_exp_f32 v26, v26
    v_exp_f32 v27, v27
    v_exp_f32 v28, v28
    s_waitcnt vmcnt(5)
    v_mfma_f32_32x32x16_bf16 v[120:135], v[184:187], v[192:195], v[120:135]
    v_exp_f32 v29, v29
    v_exp_f32 v30, v30
    v_exp_f32 v31, v31
    v_exp_f32 v32, v32
    v_exp_f32 v33, v33
    s_waitcnt lgkmcnt(1)
    v_smfmac_f32_32x32x32_bf16 v[212:227], v[96:99], v[24:31], v100
    v_exp_f32 v34, v34
    v_exp_f32 v35, v35
    v_exp_f32 v36, v36
    s_waitcnt lgkmcnt(0)
    v_mfma_f32_32x32x16_bf16 v[16:31], v[88:91], v[80:83], 0
    v_exp_f32 v37, v37
    v_exp_f32 v38, v38
    buffer_load_dwordx4 v[180:183], v5, s[52:55], s8 offen offset:1024 sc1
    s_add_u32 s8, s8, 16384
    v_exp_f32 v39, v39
    v_exp_f32 v40, v40
    v_exp_f32 v41, v41
    v_smfmac_f32_32x32x32_bf16 v[228:243], v[92:95], v[32:39], v100
    ds_read_b128 v[92:95], v245 offset:10320
    v_exp_f32 v42, v42
    v_exp_f32 v43, v43
    v_exp_f32 v44, v44
    s_waitcnt vmcnt(5)
    v_mfma_f32_32x32x16_bf16 v[136:151], v[196:199], v[188:191], v[136:151]
    v_exp_f32 v45, v45
    v_exp_f32 v46, v46
    buffer_load_dwordx4 v[184:187], v5, s[52:55], s8 offen offset:0 sc1
    v_exp_f32 v47, v47
    v_mfma_f32_32x32x16_bf16 v[152:167], v[196:199], v[192:195], v[152:167]
    s_setprio 0
    v_exp_f32 v16, v16
    v_exp_f32 v17, v17
    v_smfmac_f32_32x32x32_bf16 v[228:243], v[96:99], v[40:47], v100
    ds_read_b128 v[96:99], v246 offset:10320
    v_exp_f32 v18, v18
    v_exp_f32 v19, v19
    v_exp_f32 v20, v20
    v_mfma_f32_32x32x16_bf16 v[32:47], v[88:91], v[84:87], 0
    ds_read_b128 v[88:91], v244 offset:12384
    v_exp_f32 v21, v21
    v_exp_f32 v22, v22
    v_exp_f32 v23, v23
    v_exp_f32 v24, v24
    v_exp_f32 v25, v25
    s_waitcnt lgkmcnt(2)
    v_smfmac_f32_32x32x32_bf16 v[212:227], v[92:95], v[16:23], v100
    s_setprio 1
    v_exp_f32 v26, v26
    v_exp_f32 v27, v27
    v_exp_f32 v28, v28
    v_exp_f32 v29, v29
    v_exp_f32 v30, v30
    buffer_load_dwordx4 v[188:191], v5, s[68:71], s8 offen offset:0 sc1
    buffer_load_dwordx4 v5, s[60:63], s10 offen offset:2048 sc1 lds
    v_exp_f32 v31, v31
    s_waitcnt vmcnt(6)
    v_mfma_f32_32x32x16_bf16 v[104:119], v[168:171], v[172:175], v[104:119]
    v_exp_f32 v32, v32
    v_exp_f32 v33, v33
    s_waitcnt lgkmcnt(1)
    v_smfmac_f32_32x32x32_bf16 v[212:227], v[96:99], v[24:31], v100
    v_exp_f32 v34, v34
    v_exp_f32 v35, v35
    v_exp_f32 v36, v36
    s_waitcnt lgkmcnt(0)
    v_mfma_f32_32x32x16_bf16 v[16:31], v[88:91], v[80:83], 0
    v_exp_f32 v37, v37
    v_exp_f32 v38, v38
    buffer_load_dwordx4 v[192:195], v5, s[68:71], s8 offen offset:1024 sc1
    v_exp_f32 v39, v39
    v_exp_f32 v40, v40
    v_exp_f32 v41, v41
    v_smfmac_f32_32x32x32_bf16 v[228:243], v[92:95], v[32:39], v100
    ds_read_b128 v[92:95], v245 offset:12384
    v_exp_f32 v42, v42
    v_exp_f32 v43, v43
    v_exp_f32 v44, v44
    s_waitcnt vmcnt(5)
    v_mfma_f32_32x32x16_bf16 v[120:135], v[168:171], v[176:179], v[120:135]
    v_exp_f32 v45, v45
    v_exp_f32 v46, v46
    v_exp_f32 v47, v47
    s_setprio 0
    v_exp_f32 v16, v16
    v_exp_f32 v17, v17
    v_smfmac_f32_32x32x32_bf16 v[228:243], v[96:99], v[40:47], v100
    ds_read_b128 v[96:99], v246 offset:12384
    v_exp_f32 v18, v18
    v_exp_f32 v19, v19
    v_exp_f32 v20, v20
    v_mfma_f32_32x32x16_bf16 v[32:47], v[88:91], v[84:87], 0
    ds_read_b128 v[88:91], v244 offset:14448
    v_exp_f32 v21, v21
    v_exp_f32 v22, v22
    buffer_load_dwordx4 v[196:199], v5, s[52:55], s8 offen offset:1024 sc1
    s_add_u32 s8, s8, 16384
    v_exp_f32 v23, v23
    v_exp_f32 v24, v24
    v_exp_f32 v25, v25
    s_waitcnt lgkmcnt(2)
    v_smfmac_f32_32x32x32_bf16 v[212:227], v[92:95], v[16:23], v100
    s_setprio 1
    v_exp_f32 v26, v26
    v_exp_f32 v27, v27
    v_exp_f32 v28, v28
    s_waitcnt vmcnt(5)
    v_mfma_f32_32x32x16_bf16 v[136:151], v[180:183], v[172:175], v[136:151]
    v_exp_f32 v29, v29
    v_exp_f32 v30, v30
    buffer_load_dwordx4 v[168:171], v5, s[52:55], s8 offen offset:0 sc1
    v_exp_f32 v31, v31
    v_mfma_f32_32x32x16_bf16 v[152:167], v[180:183], v[176:179], v[152:167]
    v_exp_f32 v32, v32
    v_exp_f32 v33, v33
    s_waitcnt lgkmcnt(1)
    v_smfmac_f32_32x32x32_bf16 v[212:227], v[96:99], v[24:31], v100
    v_exp_f32 v34, v34
    v_exp_f32 v35, v35
    v_exp_f32 v36, v36
    s_waitcnt lgkmcnt(0)
    v_mfma_f32_32x32x16_bf16 v[16:31], v[88:91], v[80:83], 0
    v_exp_f32 v37, v37
    v_exp_f32 v38, v38
    v_exp_f32 v39, v39
    v_exp_f32 v40, v40
    v_exp_f32 v41, v41
    v_smfmac_f32_32x32x32_bf16 v[228:243], v[92:95], v[32:39], v100
    ds_read_b128 v[92:95], v245 offset:14448
    v_exp_f32 v42, v42
    v_exp_f32 v43, v43
    v_exp_f32 v44, v44
    v_exp_f32 v45, v45
    v_exp_f32 v46, v46
    buffer_load_dwordx4 v[172:175], v5, s[68:71], s8 offen offset:0 sc1
    buffer_load_dwordx4 v5, s[60:63], s10 offen offset:3072 sc1 lds
    s_add_u32 s10, s10, 4096
    v_exp_f32 v47, v47
    s_waitcnt vmcnt(6)
    v_mfma_f32_32x32x16_bf16 v[104:119], v[184:187], v[188:191], v[104:119]
    s_setprio 0
    v_exp_f32 v16, v16
    v_exp_f32 v17, v17
    v_smfmac_f32_32x32x32_bf16 v[228:243], v[96:99], v[40:47], v100
    ds_read_b128 v[96:99], v246 offset:14448
    v_exp_f32 v18, v18
    v_exp_f32 v19, v19
    v_exp_f32 v20, v20
    v_mfma_f32_32x32x16_bf16 v[32:47], v[88:91], v[84:87], 0
    ds_read_b128 v[88:91], v244 offset:16512
    v_exp_f32 v21, v21
    v_exp_f32 v22, v22
    buffer_load_dwordx4 v[176:179], v5, s[68:71], s8 offen offset:1024 sc1
    v_exp_f32 v23, v23
    v_exp_f32 v24, v24
    v_exp_f32 v25, v25
    s_waitcnt lgkmcnt(2)
    v_smfmac_f32_32x32x32_bf16 v[212:227], v[92:95], v[16:23], v100
    s_setprio 1
    v_exp_f32 v26, v26
    v_exp_f32 v27, v27
    v_exp_f32 v28, v28
    s_waitcnt vmcnt(5)
    v_mfma_f32_32x32x16_bf16 v[120:135], v[184:187], v[192:195], v[120:135]
    v_exp_f32 v29, v29
    v_exp_f32 v30, v30
    buffer_load_dwordx4 v[180:183], v5, s[52:55], s8 offen offset:1024 sc1
    s_add_u32 s8, s8, 16384
    v_exp_f32 v31, v31
    s_waitcnt vmcnt(5)
    v_mfma_f32_32x32x16_bf16 v[136:151], v[196:199], v[188:191], v[136:151]
    v_exp_f32 v32, v32
    v_exp_f32 v33, v33
    s_waitcnt lgkmcnt(1)
    v_smfmac_f32_32x32x32_bf16 v[212:227], v[96:99], v[24:31], v100
    v_exp_f32 v34, v34
    v_exp_f32 v35, v35
    v_exp_f32 v36, v36
    s_waitcnt lgkmcnt(0)
    v_mfma_f32_32x32x16_bf16 v[16:31], v[88:91], v[80:83], 0
    v_exp_f32 v37, v37
    v_exp_f32 v38, v38
    v_exp_f32 v39, v39
    v_exp_f32 v40, v40
    v_exp_f32 v41, v41
    v_smfmac_f32_32x32x32_bf16 v[228:243], v[92:95], v[32:39], v100
    ds_read_b128 v[92:95], v245 offset:16512
    v_exp_f32 v42, v42
    v_exp_f32 v43, v43
    v_exp_f32 v44, v44
    v_exp_f32 v45, v45
    v_exp_f32 v46, v46
    buffer_load_dwordx4 v[184:187], v5, s[52:55], s8 offen offset:0 sc1
    v_exp_f32 v47, v47
    v_mfma_f32_32x32x16_bf16 v[152:167], v[196:199], v[192:195], v[152:167]
    s_setprio 0
    v_exp_f32 v16, v16
    v_exp_f32 v17, v17
    v_smfmac_f32_32x32x32_bf16 v[228:243], v[96:99], v[40:47], v100
    ds_read_b128 v[96:99], v246 offset:16512
    v_exp_f32 v18, v18
    v_exp_f32 v19, v19
    v_exp_f32 v20, v20
    v_mfma_f32_32x32x16_bf16 v[32:47], v[88:91], v[84:87], 0
    ds_read_b128 v[88:91], v244 offset:18576
    v_exp_f32 v21, v21
    v_exp_f32 v22, v22
    buffer_load_dwordx4 v[188:191], v5, s[68:71], s8 offen offset:0 sc1
    v_exp_f32 v23, v23
    v_exp_f32 v24, v24
    v_exp_f32 v25, v25
    s_waitcnt lgkmcnt(2)
    v_smfmac_f32_32x32x32_bf16 v[212:227], v[92:95], v[16:23], v100
    s_setprio 1
    v_exp_f32 v26, v26
    v_exp_f32 v27, v27
    v_exp_f32 v28, v28
    s_waitcnt vmcnt(5)
    v_mfma_f32_32x32x16_bf16 v[104:119], v[168:171], v[172:175], v[104:119]
    v_exp_f32 v29, v29
    v_exp_f32 v30, v30
    s_add_u32 m0, s10, 66048
    s_nop 0
    buffer_load_dwordx4 v5, s[60:63], s10 offen offset:0 sc1 lds
    v_exp_f32 v31, v31
    v_exp_f32 v32, v32
    v_exp_f32 v33, v33
    s_waitcnt lgkmcnt(1)
    v_smfmac_f32_32x32x32_bf16 v[212:227], v[96:99], v[24:31], v100
    v_exp_f32 v34, v34
    v_exp_f32 v35, v35
    v_exp_f32 v36, v36
    s_waitcnt lgkmcnt(0)
    v_mfma_f32_32x32x16_bf16 v[16:31], v[88:91], v[80:83], 0
    v_exp_f32 v37, v37
    v_exp_f32 v38, v38
    buffer_load_dwordx4 v[192:195], v5, s[68:71], s8 offen offset:1024 sc1
    v_exp_f32 v39, v39
    v_exp_f32 v40, v40
    v_exp_f32 v41, v41
    v_smfmac_f32_32x32x32_bf16 v[228:243], v[92:95], v[32:39], v100
    ds_read_b128 v[92:95], v245 offset:18576
    v_exp_f32 v42, v42
    v_exp_f32 v43, v43
    v_exp_f32 v44, v44
    s_waitcnt vmcnt(5)
    v_mfma_f32_32x32x16_bf16 v[120:135], v[168:171], v[176:179], v[120:135]
    v_exp_f32 v45, v45
    v_exp_f32 v46, v46
    buffer_load_dwordx4 v[196:199], v5, s[52:55], s8 offen offset:1024 sc1
    s_add_u32 s8, s8, 16384
    v_exp_f32 v47, v47
    s_waitcnt vmcnt(5)
    v_mfma_f32_32x32x16_bf16 v[136:151], v[180:183], v[172:175], v[136:151]
    s_setprio 0
    v_exp_f32 v16, v16
    v_exp_f32 v17, v17
    v_smfmac_f32_32x32x32_bf16 v[228:243], v[96:99], v[40:47], v100
    ds_read_b128 v[96:99], v246 offset:18576
    v_exp_f32 v18, v18
    v_exp_f32 v19, v19
    v_exp_f32 v20, v20
    v_mfma_f32_32x32x16_bf16 v[32:47], v[88:91], v[84:87], 0
    ds_read_b128 v[88:91], v244 offset:20640
    v_exp_f32 v21, v21
    v_exp_f32 v22, v22
    v_exp_f32 v23, v23
    v_exp_f32 v24, v24
    v_exp_f32 v25, v25
    s_waitcnt lgkmcnt(2)
    v_smfmac_f32_32x32x32_bf16 v[212:227], v[92:95], v[16:23], v100
    s_setprio 1
    v_exp_f32 v26, v26
    v_exp_f32 v27, v27
    v_exp_f32 v28, v28
    v_exp_f32 v29, v29
    v_exp_f32 v30, v30
    buffer_load_dwordx4 v[168:171], v5, s[52:55], s8 offen offset:0 sc1
    v_exp_f32 v31, v31
    v_mfma_f32_32x32x16_bf16 v[152:167], v[180:183], v[176:179], v[152:167]
    v_exp_f32 v32, v32
    v_exp_f32 v33, v33
    s_waitcnt lgkmcnt(1)
    v_smfmac_f32_32x32x32_bf16 v[212:227], v[96:99], v[24:31], v100
    v_exp_f32 v34, v34
    v_exp_f32 v35, v35
    v_exp_f32 v36, v36
    s_waitcnt lgkmcnt(0)
    v_mfma_f32_32x32x16_bf16 v[16:31], v[88:91], v[80:83], 0
    v_exp_f32 v37, v37
    v_exp_f32 v38, v38
    buffer_load_dwordx4 v[172:175], v5, s[68:71], s8 offen offset:0 sc1
    v_exp_f32 v39, v39
    v_exp_f32 v40, v40
    v_exp_f32 v41, v41
    v_smfmac_f32_32x32x32_bf16 v[228:243], v[92:95], v[32:39], v100
    ds_read_b128 v[92:95], v245 offset:20640
    v_exp_f32 v42, v42
    v_exp_f32 v43, v43
    v_exp_f32 v44, v44
    s_waitcnt vmcnt(5)
    v_mfma_f32_32x32x16_bf16 v[104:119], v[184:187], v[188:191], v[104:119]
    v_exp_f32 v45, v45
    v_exp_f32 v46, v46
    buffer_load_dwordx4 v5, s[60:63], s10 offen offset:1024 sc1 lds
    v_exp_f32 v47, v47
    s_setprio 0
    v_exp_f32 v16, v16
    v_exp_f32 v17, v17
    v_smfmac_f32_32x32x32_bf16 v[228:243], v[96:99], v[40:47], v100
    ds_read_b128 v[96:99], v246 offset:20640
    v_exp_f32 v18, v18
    v_exp_f32 v19, v19
    v_exp_f32 v20, v20
    v_mfma_f32_32x32x16_bf16 v[32:47], v[88:91], v[84:87], 0
    ds_read_b128 v[88:91], v244 offset:22704
    v_exp_f32 v21, v21
    v_exp_f32 v22, v22
    buffer_load_dwordx4 v[176:179], v5, s[68:71], s8 offen offset:1024 sc1
    v_exp_f32 v23, v23
    v_exp_f32 v24, v24
    v_exp_f32 v25, v25
    s_waitcnt lgkmcnt(2)
    v_smfmac_f32_32x32x32_bf16 v[212:227], v[92:95], v[16:23], v100
    s_setprio 1
    v_exp_f32 v26, v26
    v_exp_f32 v27, v27
    v_exp_f32 v28, v28
    s_waitcnt vmcnt(5)
    v_mfma_f32_32x32x16_bf16 v[120:135], v[184:187], v[192:195], v[120:135]
    v_exp_f32 v29, v29
    v_exp_f32 v30, v30
    buffer_load_dwordx4 v[180:183], v5, s[52:55], s8 offen offset:1024 sc1
    s_add_u32 s8, s8, 16384
    v_exp_f32 v31, v31
    s_waitcnt vmcnt(5)
    v_mfma_f32_32x32x16_bf16 v[136:151], v[196:199], v[188:191], v[136:151]
    v_exp_f32 v32, v32
    v_exp_f32 v33, v33
    s_waitcnt lgkmcnt(1)
    v_smfmac_f32_32x32x32_bf16 v[212:227], v[96:99], v[24:31], v100
    v_exp_f32 v34, v34
    v_exp_f32 v35, v35
    v_exp_f32 v36, v36
    s_waitcnt lgkmcnt(0)
    v_mfma_f32_32x32x16_bf16 v[16:31], v[88:91], v[80:83], 0
    v_exp_f32 v37, v37
    v_exp_f32 v38, v38
    v_exp_f32 v39, v39
    v_exp_f32 v40, v40
    v_exp_f32 v41, v41
    v_smfmac_f32_32x32x32_bf16 v[228:243], v[92:95], v[32:39], v100
    ds_read_b128 v[92:95], v245 offset:22704
    v_exp_f32 v42, v42
    v_exp_f32 v43, v43
    v_exp_f32 v44, v44
    v_exp_f32 v45, v45
    v_exp_f32 v46, v46
    buffer_load_dwordx4 v[184:187], v5, s[52:55], s8 offen offset:0 sc1
    v_exp_f32 v47, v47
    v_mfma_f32_32x32x16_bf16 v[152:167], v[196:199], v[192:195], v[152:167]
    s_setprio 0
    v_exp_f32 v16, v16
    v_exp_f32 v17, v17
    v_smfmac_f32_32x32x32_bf16 v[228:243], v[96:99], v[40:47], v100
    ds_read_b128 v[96:99], v246 offset:22704
    v_exp_f32 v18, v18
    v_exp_f32 v19, v19
    v_exp_f32 v20, v20
    v_mfma_f32_32x32x16_bf16 v[32:47], v[88:91], v[84:87], 0
    ds_read_b128 v[88:91], v244 offset:24768
    v_exp_f32 v21, v21
    v_exp_f32 v22, v22
    buffer_load_dwordx4 v[188:191], v5, s[68:71], s8 offen offset:0 sc1
    v_exp_f32 v23, v23
    v_exp_f32 v24, v24
    v_exp_f32 v25, v25
    s_waitcnt lgkmcnt(2)
    v_smfmac_f32_32x32x32_bf16 v[212:227], v[92:95], v[16:23], v100
    s_setprio 1
    v_exp_f32 v26, v26
    v_exp_f32 v27, v27
    v_exp_f32 v28, v28
    s_waitcnt vmcnt(5)
    v_mfma_f32_32x32x16_bf16 v[104:119], v[168:171], v[172:175], v[104:119]
    v_exp_f32 v29, v29
    v_exp_f32 v30, v30
    buffer_load_dwordx4 v5, s[60:63], s10 offen offset:2048 sc1 lds
    v_exp_f32 v31, v31
    v_exp_f32 v32, v32
    v_exp_f32 v33, v33
    s_waitcnt lgkmcnt(1)
    v_smfmac_f32_32x32x32_bf16 v[212:227], v[96:99], v[24:31], v100
    v_exp_f32 v34, v34
    v_exp_f32 v35, v35
    v_exp_f32 v36, v36
    s_waitcnt lgkmcnt(0)
    v_mfma_f32_32x32x16_bf16 v[16:31], v[88:91], v[80:83], 0
    v_exp_f32 v37, v37
    v_exp_f32 v38, v38
    buffer_load_dwordx4 v[192:195], v5, s[68:71], s8 offen offset:1024 sc1
    v_exp_f32 v39, v39
    v_exp_f32 v40, v40
    v_exp_f32 v41, v41
    v_smfmac_f32_32x32x32_bf16 v[228:243], v[92:95], v[32:39], v100
    ds_read_b128 v[92:95], v245 offset:24768
    v_exp_f32 v42, v42
    v_exp_f32 v43, v43
    v_exp_f32 v44, v44
    s_waitcnt vmcnt(5)
    v_mfma_f32_32x32x16_bf16 v[120:135], v[168:171], v[176:179], v[120:135]
    v_exp_f32 v45, v45
    v_exp_f32 v46, v46
    buffer_load_dwordx4 v[196:199], v5, s[52:55], s8 offen offset:1024 sc1
    s_add_u32 s8, s8, 16384
    v_exp_f32 v47, v47
    s_waitcnt vmcnt(5)
    v_mfma_f32_32x32x16_bf16 v[136:151], v[180:183], v[172:175], v[136:151]
    s_setprio 0
    v_exp_f32 v16, v16
    v_exp_f32 v17, v17
    v_smfmac_f32_32x32x32_bf16 v[228:243], v[96:99], v[40:47], v100
    ds_read_b128 v[96:99], v246 offset:24768
    v_exp_f32 v18, v18
    v_exp_f32 v19, v19
    v_exp_f32 v20, v20
    v_mfma_f32_32x32x16_bf16 v[32:47], v[88:91], v[84:87], 0
    ds_read_b128 v[88:91], v244 offset:26832
    v_exp_f32 v21, v21
    v_exp_f32 v22, v22
    v_exp_f32 v23, v23
    v_exp_f32 v24, v24
    v_exp_f32 v25, v25
    s_waitcnt lgkmcnt(2)
    v_smfmac_f32_32x32x32_bf16 v[212:227], v[92:95], v[16:23], v100
    s_setprio 1
    v_exp_f32 v26, v26
    v_exp_f32 v27, v27
    v_exp_f32 v28, v28
    v_exp_f32 v29, v29
    v_exp_f32 v30, v30
    buffer_load_dwordx4 v[168:171], v5, s[52:55], s8 offen offset:0 sc1
    v_exp_f32 v31, v31
    v_mfma_f32_32x32x16_bf16 v[152:167], v[180:183], v[176:179], v[152:167]
    v_exp_f32 v32, v32
    v_exp_f32 v33, v33
    s_waitcnt lgkmcnt(1)
    v_smfmac_f32_32x32x32_bf16 v[212:227], v[96:99], v[24:31], v100
    v_exp_f32 v34, v34
    v_exp_f32 v35, v35
    v_exp_f32 v36, v36
    s_waitcnt lgkmcnt(0)
    v_mfma_f32_32x32x16_bf16 v[16:31], v[88:91], v[80:83], 0
    v_exp_f32 v37, v37
    v_exp_f32 v38, v38
    buffer_load_dwordx4 v[172:175], v5, s[68:71], s8 offen offset:0 sc1
    v_exp_f32 v39, v39
    v_exp_f32 v40, v40
    v_exp_f32 v41, v41
    v_smfmac_f32_32x32x32_bf16 v[228:243], v[92:95], v[32:39], v100
    ds_read_b128 v[92:95], v245 offset:26832
    v_exp_f32 v42, v42
    v_exp_f32 v43, v43
    v_exp_f32 v44, v44
    s_waitcnt vmcnt(5)
    v_mfma_f32_32x32x16_bf16 v[104:119], v[184:187], v[188:191], v[104:119]
    v_exp_f32 v45, v45
    v_exp_f32 v46, v46
    buffer_load_dwordx4 v5, s[60:63], s10 offen offset:3072 sc1 lds
    v_exp_f32 v47, v47
    s_setprio 0
    v_exp_f32 v16, v16
    v_exp_f32 v17, v17
    v_smfmac_f32_32x32x32_bf16 v[228:243], v[96:99], v[40:47], v100
    ds_read_b128 v[96:99], v246 offset:26832
    v_exp_f32 v18, v18
    v_exp_f32 v19, v19
    v_exp_f32 v20, v20
    v_mfma_f32_32x32x16_bf16 v[32:47], v[88:91], v[84:87], 0
    ds_read_b128 v[88:91], v244 offset:28896
    v_exp_f32 v21, v21
    v_exp_f32 v22, v22
    buffer_load_dwordx4 v[176:179], v5, s[68:71], s8 offen offset:1024 sc1
    v_exp_f32 v23, v23
    v_exp_f32 v24, v24
    v_exp_f32 v25, v25
    s_waitcnt lgkmcnt(2)
    v_smfmac_f32_32x32x32_bf16 v[212:227], v[92:95], v[16:23], v100
    s_setprio 1
    v_exp_f32 v26, v26
    v_exp_f32 v27, v27
    v_exp_f32 v28, v28
    s_waitcnt vmcnt(5)
    v_mfma_f32_32x32x16_bf16 v[120:135], v[184:187], v[192:195], v[120:135]
    v_exp_f32 v29, v29
    v_exp_f32 v30, v30
    buffer_load_dwordx4 v[180:183], v5, s[52:55], s8 offen offset:1024 sc1
    s_add_u32 s8, s8, 16384
    v_exp_f32 v31, v31
    s_waitcnt vmcnt(5)
    v_mfma_f32_32x32x16_bf16 v[136:151], v[196:199], v[188:191], v[136:151]
    v_exp_f32 v32, v32
    v_exp_f32 v33, v33
    s_waitcnt lgkmcnt(1)
    v_smfmac_f32_32x32x32_bf16 v[212:227], v[96:99], v[24:31], v100
    v_exp_f32 v34, v34
    v_exp_f32 v35, v35
    v_exp_f32 v36, v36
    s_waitcnt lgkmcnt(0)
    v_mfma_f32_32x32x16_bf16 v[16:31], v[88:91], v[80:83], 0
    v_exp_f32 v37, v37
    v_exp_f32 v38, v38
    v_exp_f32 v39, v39
    v_exp_f32 v40, v40
    v_exp_f32 v41, v41
    v_smfmac_f32_32x32x32_bf16 v[228:243], v[92:95], v[32:39], v100
    ds_read_b128 v[92:95], v245 offset:28896
    v_exp_f32 v42, v42
    v_exp_f32 v43, v43
    v_exp_f32 v44, v44
    v_exp_f32 v45, v45
    v_exp_f32 v46, v46
    v_exp_f32 v47, v47
    v_mfma_f32_32x32x16_bf16 v[152:167], v[196:199], v[192:195], v[152:167]
    s_setprio 0
    v_exp_f32 v16, v16
    v_exp_f32 v17, v17
    v_smfmac_f32_32x32x32_bf16 v[228:243], v[96:99], v[40:47], v100
    ds_read_b128 v[96:99], v246 offset:28896
    v_exp_f32 v18, v18
    v_exp_f32 v19, v19
    v_exp_f32 v20, v20
    v_mfma_f32_32x32x16_bf16 v[32:47], v[88:91], v[84:87], 0
    ds_read_b128 v[88:91], v244 offset:30960
    v_exp_f32 v21, v21
    v_exp_f32 v22, v22
    v_exp_f32 v23, v23
    v_exp_f32 v24, v24
    v_exp_f32 v25, v25
    s_waitcnt lgkmcnt(2)
    v_smfmac_f32_32x32x32_bf16 v[212:227], v[92:95], v[16:23], v100
    s_setprio 1
    v_exp_f32 v26, v26
    v_exp_f32 v27, v27
    v_exp_f32 v28, v28
    s_waitcnt vmcnt(3)
    v_mfma_f32_32x32x16_bf16 v[104:119], v[168:171], v[172:175], v[104:119]
    v_exp_f32 v29, v29
    v_exp_f32 v30, v30
    v_exp_f32 v31, v31
    v_exp_f32 v32, v32
    v_exp_f32 v33, v33
    s_waitcnt lgkmcnt(1)
    v_smfmac_f32_32x32x32_bf16 v[212:227], v[96:99], v[24:31], v100
    v_exp_f32 v34, v34
    v_exp_f32 v35, v35
    v_exp_f32 v36, v36
    s_waitcnt lgkmcnt(0)
    v_mfma_f32_32x32x16_bf16 v[16:31], v[88:91], v[80:83], 0
    v_exp_f32 v37, v37
    v_exp_f32 v38, v38
    v_exp_f32 v39, v39
    v_exp_f32 v40, v40
    v_exp_f32 v41, v41
    v_smfmac_f32_32x32x32_bf16 v[228:243], v[92:95], v[32:39], v100
    ds_read_b128 v[92:95], v245 offset:30960
    v_exp_f32 v42, v42
    v_exp_f32 v43, v43
    v_exp_f32 v44, v44
    s_waitcnt vmcnt(1)
    v_mfma_f32_32x32x16_bf16 v[120:135], v[168:171], v[176:179], v[120:135]
    v_exp_f32 v45, v45
    v_exp_f32 v46, v46
    v_exp_f32 v47, v47
    s_waitcnt vmcnt(0)
    v_mfma_f32_32x32x16_bf16 v[136:151], v[180:183], v[172:175], v[136:151]
    s_setprio 0
    v_exp_f32 v16, v16
    v_exp_f32 v17, v17
    v_smfmac_f32_32x32x32_bf16 v[228:243], v[96:99], v[40:47], v100
    ds_read_b128 v[96:99], v246 offset:30960
    v_exp_f32 v18, v18
    v_exp_f32 v19, v19
    v_exp_f32 v20, v20
    v_mfma_f32_32x32x16_bf16 v[32:47], v[88:91], v[84:87], 0
    v_exp_f32 v21, v21
    v_exp_f32 v22, v22
    v_exp_f32 v23, v23
    v_exp_f32 v24, v24
    v_exp_f32 v25, v25
    s_waitcnt lgkmcnt(1)
    v_smfmac_f32_32x32x32_bf16 v[212:227], v[92:95], v[16:23], v100
    s_setprio 1
    v_exp_f32 v26, v26
    v_exp_f32 v27, v27
    v_exp_f32 v28, v28
    v_exp_f32 v29, v29
    v_exp_f32 v30, v30
    v_exp_f32 v31, v31
    v_mfma_f32_32x32x16_bf16 v[152:167], v[180:183], v[176:179], v[152:167]
    v_exp_f32 v32, v32
    v_exp_f32 v33, v33
    s_waitcnt lgkmcnt(0)
    v_smfmac_f32_32x32x32_bf16 v[212:227], v[96:99], v[24:31], v100
    v_exp_f32 v34, v34
    v_exp_f32 v35, v35
    v_exp_f32 v36, v36
    v_exp_f32 v37, v37
    v_exp_f32 v38, v38
    v_exp_f32 v39, v39
    v_exp_f32 v40, v40
    v_exp_f32 v41, v41
    v_smfmac_f32_32x32x32_bf16 v[228:243], v[92:95], v[32:39], v100
    v_exp_f32 v42, v42
    v_exp_f32 v43, v43
    v_exp_f32 v44, v44
    v_exp_f32 v45, v45
    v_exp_f32 v46, v46
    ds_write_b128 v1, v[212:215]
    ds_write_b128 v1, v[216:219] offset:1024
    ds_write_b32 v2, v220 offset:2048
    v_exp_f32 v47, v47
    s_nop 1
    v_smfmac_f32_32x32x32_bf16 v[228:243], v[96:99], v[40:47], v100
    s_setprio 0
    s_waitcnt lgkmcnt(0)
    s_barrier
    ds_read_b128 v[212:215], v3
    ds_read_b128 v[216:219], v3 offset:1024
    ds_read_b32 v220, v4 offset:2048
    s_waitcnt lgkmcnt(2)
    s_nop 4
    v_add_f32 v212, v212, v228
    v_add_f32 v213, v213, v229
    v_add_f32 v214, v214, v230
    v_add_f32 v215, v215, v231
    s_waitcnt lgkmcnt(1)
    v_add_f32 v216, v216, v232
    v_add_f32 v217, v217, v233
    v_add_f32 v218, v218, v234
    v_add_f32 v219, v219, v235
    s_waitcnt lgkmcnt(0)
    v_add_f32 v220, v220, v236
    v_mov_b32 v101, v220
    s_nop 1
    v_permlane32_swap_b32 v220, v101
    v_max3_f32 v102, |v212|, |v213|, |v214|
    v_max3_f32 v102, |v215|, |v216|, v102
    v_max3_f32 v102, |v217|, |v218|, v102
    v_max3_f32 v102, |v219|, v220, v102
    v_cmp_gt_f32 vcc, 0x71800000, v102
    s_mov_b32 s74, 0x21800000
    v_cmp_lt_f32 s[14:15], s74, v220
    s_nop 1
    s_and_b64 vcc, vcc, s[14:15]
    s_cmp_eq_u64 vcc, exec
    s_nop 0
    s_cbranch_scc0 L_slow
L_fin:
    v_rcp_f32 v101, v220
    s_nop 0
    v_mul_f32 v212, v212, v101
    v_mul_f32 v213, v213, v101
    v_mul_f32 v214, v214, v101
    v_mul_f32 v215, v215, v101
    v_mul_f32 v216, v216, v101
    v_mul_f32 v217, v217, v101
    v_mul_f32 v218, v218, v101
    v_mul_f32 v219, v219, v101
    v_cvt_pk_bf16_f32 v16, v212, v213
    v_cvt_pk_bf16_f32 v17, v214, v215
    v_cvt_pk_bf16_f32 v18, v216, v217
    v_cvt_pk_bf16_f32 v19, v218, v219
    v_min_u32 v16, -2, v16
    v_min_u32 v17, -2, v17
    v_min_u32 v18, -2, v18
    v_min_u32 v19, -2, v19
    buffer_store_dwordx4 v[16:19], v5, s[64:67], s90 offen sc1
    v_xor_b32 v1, 32, v252
    v_xor_b32 v2, 64, v252
    v_xor_b32 v3, 96, v252
    v_cvt_pk_bf16_f32 v48, v104, v105
    v_cvt_pk_bf16_f32 v49, v106, v107
    v_cvt_pk_bf16_f32 v50, v108, v109
    v_cvt_pk_bf16_f32 v51, v110, v111
    ds_write_b128 v252, v[48:51] offset:0
    v_cvt_pk_bf16_f32 v52, v112, v113
    v_cvt_pk_bf16_f32 v53, v114, v115
    v_cvt_pk_bf16_f32 v54, v116, v117
    v_cvt_pk_bf16_f32 v55, v118, v119
    ds_write_b128 v1, v[52:55] offset:0
    v_cvt_pk_bf16_f32 v56, v120, v121
    v_cvt_pk_bf16_f32 v57, v122, v123
    v_cvt_pk_bf16_f32 v58, v124, v125
    v_cvt_pk_bf16_f32 v59, v126, v127
    ds_write_b128 v252, v[56:59] offset:4096
    v_cvt_pk_bf16_f32 v60, v128, v129
    v_cvt_pk_bf16_f32 v61, v130, v131
    v_cvt_pk_bf16_f32 v62, v132, v133
    v_cvt_pk_bf16_f32 v63, v134, v135
    ds_write_b128 v1, v[60:63] offset:4096
    v_cvt_pk_bf16_f32 v64, v136, v137
    v_cvt_pk_bf16_f32 v65, v138, v139
    v_cvt_pk_bf16_f32 v66, v140, v141
    v_cvt_pk_bf16_f32 v67, v142, v143
    ds_write_b128 v2, v[64:67] offset:0
    v_cvt_pk_bf16_f32 v68, v144, v145
    v_cvt_pk_bf16_f32 v69, v146, v147
    v_cvt_pk_bf16_f32 v70, v148, v149
    v_cvt_pk_bf16_f32 v71, v150, v151
    ds_write_b128 v3, v[68:71] offset:0
    v_cvt_pk_bf16_f32 v72, v152, v153
    v_cvt_pk_bf16_f32 v73, v154, v155
    v_cvt_pk_bf16_f32 v74, v156, v157
    v_cvt_pk_bf16_f32 v75, v158, v159
    ds_write_b128 v2, v[72:75] offset:4096
    v_cvt_pk_bf16_f32 v76, v160, v161
    v_cvt_pk_bf16_f32 v77, v162, v163
    v_cvt_pk_bf16_f32 v78, v164, v165
    v_cvt_pk_bf16_f32 v79, v166, v167
    ds_write_b128 v3, v[76:79] offset:4096
    s_add_u32 s15, s73, 66048
    v_add_u32 v8, s15, v5
    ds_read_b128 v[104:107], v8 offset:0
    ds_read_b128 v[108:111], v8 offset:1024
    ds_read_b128 v[112:115], v8 offset:2048
    ds_read_b128 v[116:119], v8 offset:3072
    ds_read_b128 v[120:123], v8 offset:4096
    ds_read_b128 v[124:127], v8 offset:5120
    ds_read_b128 v[128:131], v8 offset:6144
    ds_read_b128 v[132:135], v8 offset:7168
    ds_read_b128 v[136:139], v8 offset:8192
    ds_read_b128 v[140:143], v8 offset:9216
    ds_read_b128 v[144:147], v8 offset:10240
    ds_read_b128 v[148:151], v8 offset:11264
    ds_read_b128 v[152:155], v8 offset:12288
    ds_read_b128 v[156:159], v8 offset:13312
    ds_read_b128 v[160:163], v8 offset:14336
    ds_read_b128 v[164:167], v8 offset:15360
    v_xor_b32 v6, 16, v250
    v_lshlrev_b32 v80, 16, v204
    v_and_b32 v81, 0xffff0000, v204
    v_lshlrev_b32 v82, 16, v205
    v_and_b32 v83, 0xffff0000, v205
    v_lshlrev_b32 v84, 16, v206
    v_and_b32 v85, 0xffff0000, v206
    v_lshlrev_b32 v86, 16, v207
    v_and_b32 v87, 0xffff0000, v207
    s_mov_b32 s6, 0x00003f80
    s_mov_b32 s7, 0x3f800000
    s_waitcnt lgkmcnt(0)
    s_barrier
    s_add_u32 s14, s11, 0
    buffer_load_dwordx4 v[212:215], v5, s[64:67], s14 offen offset:0 sc1
    s_add_u32 s14, s11, 0
    buffer_load_dwordx4 v[216:219], v5, s[64:67], s14 offen offset:2048 sc1
    s_add_u32 s14, s11, 4096
    buffer_load_dwordx4 v[220:223], v5, s[64:67], s14 offen offset:0 sc1
    s_add_u32 s14, s11, 4096
    buffer_load_dwordx4 v[224:227], v5, s[64:67], s14 offen offset:2048 sc1
    s_add_u32 s14, s11, 8192
    buffer_load_dwordx4 v[228:231], v5, s[64:67], s14 offen offset:0 sc1
    s_add_u32 s14, s11, 8192
    buffer_load_dwordx4 v[232:235], v5, s[64:67], s14 offen offset:2048 sc1
    s_add_u32 s14, s11, 12288
    buffer_load_dwordx4 v[236:239], v5, s[64:67], s14 offen offset:0 sc1
    s_add_u32 s14, s11, 12288
    buffer_load_dwordx4 v[240:243], v5, s[64:67], s14 offen offset:2048 sc1
    ds_read_b128 v[168:171], v253 offset:0
    ds_read_b128 v[172:175], v253 offset:8192
    ds_read_b128 v[176:179], v253 offset:16384
    ds_read_b128 v[180:183], v253 offset:24576
    ds_read_b128 v[184:187], v253 offset:32768
    ds_read_b128 v[188:191], v253 offset:40960
    ds_read_b128 v[192:195], v253 offset:49152
    ds_read_b128 v[196:199], v253 offset:57344
    s_waitcnt lgkmcnt(7)
    v_dot2_f32_bf16 v80, v168, s6, v80
    v_dot2_f32_bf16 v81, v168, s7, v81
    v_dot2_f32_bf16 v82, v169, s6, v82
    v_dot2_f32_bf16 v83, v169, s7, v83
    v_dot2_f32_bf16 v84, v170, s6, v84
    v_dot2_f32_bf16 v85, v170, s7, v85
    v_dot2_f32_bf16 v86, v171, s6, v86
    v_dot2_f32_bf16 v87, v171, s7, v87
    s_waitcnt lgkmcnt(6)
    v_dot2_f32_bf16 v80, v172, s6, v80
    v_dot2_f32_bf16 v81, v172, s7, v81
    v_dot2_f32_bf16 v82, v173, s6, v82
    v_dot2_f32_bf16 v83, v173, s7, v83
    v_dot2_f32_bf16 v84, v174, s6, v84
    v_dot2_f32_bf16 v85, v174, s7, v85
    v_dot2_f32_bf16 v86, v175, s6, v86
    v_dot2_f32_bf16 v87, v175, s7, v87
    s_waitcnt lgkmcnt(5)
    v_dot2_f32_bf16 v80, v176, s6, v80
    v_dot2_f32_bf16 v81, v176, s7, v81
    v_dot2_f32_bf16 v82, v177, s6, v82
    v_dot2_f32_bf16 v83, v177, s7, v83
    v_dot2_f32_bf16 v84, v178, s6, v84
    v_dot2_f32_bf16 v85, v178, s7, v85
    v_dot2_f32_bf16 v86, v179, s6, v86
    v_dot2_f32_bf16 v87, v179, s7, v87
    s_waitcnt lgkmcnt(4)
    v_dot2_f32_bf16 v80, v180, s6, v80
    v_dot2_f32_bf16 v81, v180, s7, v81
    v_dot2_f32_bf16 v82, v181, s6, v82
    v_dot2_f32_bf16 v83, v181, s7, v83
    v_dot2_f32_bf16 v84, v182, s6, v84
    v_dot2_f32_bf16 v85, v182, s7, v85
    v_dot2_f32_bf16 v86, v183, s6, v86
    v_dot2_f32_bf16 v87, v183, s7, v87
    s_waitcnt lgkmcnt(3)
    v_dot2_f32_bf16 v80, v184, s6, v80
    v_dot2_f32_bf16 v81, v184, s7, v81
    v_dot2_f32_bf16 v82, v185, s6, v82
    v_dot2_f32_bf16 v83, v185, s7, v83
    v_dot2_f32_bf16 v84, v186, s6, v84
    v_dot2_f32_bf16 v85, v186, s7, v85
    v_dot2_f32_bf16 v86, v187, s6, v86
    v_dot2_f32_bf16 v87, v187, s7, v87
    s_waitcnt lgkmcnt(2)
    v_dot2_f32_bf16 v80, v188, s6, v80
    v_dot2_f32_bf16 v81, v188, s7, v81
    v_dot2_f32_bf16 v82, v189, s6, v82
    v_dot2_f32_bf16 v83, v189, s7, v83
    v_dot2_f32_bf16 v84, v190, s6, v84
    v_dot2_f32_bf16 v85, v190, s7, v85
    v_dot2_f32_bf16 v86, v191, s6, v86
    v_dot2_f32_bf16 v87, v191, s7, v87
    s_waitcnt lgkmcnt(1)
    v_dot2_f32_bf16 v80, v192, s6, v80
    v_dot2_f32_bf16 v81, v192, s7, v81
    v_dot2_f32_bf16 v82, v193, s6, v82
    v_dot2_f32_bf16 v83, v193, s7, v83
    v_dot2_f32_bf16 v84, v194, s6, v84
    v_dot2_f32_bf16 v85, v194, s7, v85
    v_dot2_f32_bf16 v86, v195, s6, v86
    v_dot2_f32_bf16 v87, v195, s7, v87
    s_waitcnt lgkmcnt(0)
    v_dot2_f32_bf16 v80, v196, s6, v80
    v_dot2_f32_bf16 v81, v196, s7, v81
    v_dot2_f32_bf16 v82, v197, s6, v82
    v_dot2_f32_bf16 v83, v197, s7, v83
    v_dot2_f32_bf16 v84, v198, s6, v84
    v_dot2_f32_bf16 v85, v198, s7, v85
    v_dot2_f32_bf16 v86, v199, s6, v86
    v_dot2_f32_bf16 v87, v199, s7, v87
    s_waitcnt vmcnt(7)
    v_mfma_f32_32x32x16_bf16 v[16:31], v[104:107], v[212:215], 0
    v_max3_u32 v103, v212, v213, 0
    v_mul_f32 v48, 0xbfb8aa3b, v80
    v_mul_f32 v49, 0xbfb8aa3b, v81
    v_mul_f32 v50, 0xbfb8aa3b, v82
    v_mul_f32 v51, 0xbfb8aa3b, v83
    v_mfma_f32_32x32x16_bf16 v[32:47], v[108:111], v[212:215], 0
    v_max3_u32 v103, v214, v215, v103
    v_mul_f32 v52, 0xbfb8aa3b, v84
    v_mul_f32 v53, 0xbfb8aa3b, v85
    v_mul_f32 v54, 0xbfb8aa3b, v86
    v_mul_f32 v55, 0xbfb8aa3b, v87
    s_waitcnt vmcnt(6)
    v_mfma_f32_32x32x16_bf16 v[16:31], v[112:115], v[216:219], v[16:31]
    v_max3_u32 v103, v216, v217, v103
    v_exp_f32 v48, v48
    v_exp_f32 v49, v49
    v_exp_f32 v50, v50
    v_exp_f32 v51, v51
    v_mfma_f32_32x32x16_bf16 v[32:47], v[116:119], v[216:219], v[32:47]
    v_max3_u32 v103, v218, v219, v103
    v_exp_f32 v52, v52
    v_exp_f32 v53, v53
    v_exp_f32 v54, v54
    v_exp_f32 v55, v55
    s_waitcnt vmcnt(5)
    v_mfma_f32_32x32x16_bf16 v[16:31], v[120:123], v[220:223], v[16:31]
    v_max3_u32 v103, v220, v221, v103
    v_add_f32 v48, 1.0, v48
    v_add_f32 v49, 1.0, v49
    v_add_f32 v50, 1.0, v50
    v_add_f32 v51, 1.0, v51
    v_mfma_f32_32x32x16_bf16 v[32:47], v[124:127], v[220:223], v[32:47]
    v_max3_u32 v103, v222, v223, v103
    v_add_f32 v52, 1.0, v52
    v_add_f32 v53, 1.0, v53
    v_add_f32 v54, 1.0, v54
    v_add_f32 v55, 1.0, v55
    s_waitcnt vmcnt(4)
    v_mfma_f32_32x32x16_bf16 v[16:31], v[128:131], v[224:227], v[16:31]
    v_max3_u32 v103, v224, v225, v103
    v_rcp_f32 v48, v48
    v_rcp_f32 v49, v49
    v_rcp_f32 v50, v50
    v_rcp_f32 v51, v51
    v_mfma_f32_32x32x16_bf16 v[32:47], v[132:135], v[224:227], v[32:47]
    v_max3_u32 v103, v226, v227, v103
    v_rcp_f32 v52, v52
    v_rcp_f32 v53, v53
    v_rcp_f32 v54, v54
    v_rcp_f32 v55, v55
    s_waitcnt vmcnt(3)
    v_mfma_f32_32x32x16_bf16 v[16:31], v[136:139], v[228:231], v[16:31]
    v_max3_u32 v103, v228, v229, v103
    v_mul_f32 v80, v80, v48
    v_mul_f32 v81, v81, v49
    v_mul_f32 v82, v82, v50
    v_mul_f32 v83, v83, v51
    v_mfma_f32_32x32x16_bf16 v[32:47], v[140:143], v[228:231], v[32:47]
    v_max3_u32 v103, v230, v231, v103
    v_mul_f32 v84, v84, v52
    v_mul_f32 v85, v85, v53
    v_mul_f32 v86, v86, v54
    v_mul_f32 v87, v87, v55
    s_waitcnt vmcnt(2)
    v_mfma_f32_32x32x16_bf16 v[16:31], v[144:147], v[232:235], v[16:31]
    v_max3_u32 v103, v232, v233, v103
    v_lshlrev_b32 v88, 16, v200
    v_and_b32 v89, 0xffff0000, v200
    v_lshlrev_b32 v90, 16, v201
    v_and_b32 v91, 0xffff0000, v201
    v_mfma_f32_32x32x16_bf16 v[32:47], v[148:151], v[232:235], v[32:47]
    v_max3_u32 v103, v234, v235, v103
    v_lshlrev_b32 v92, 16, v202
    v_and_b32 v93, 0xffff0000, v202
    v_lshlrev_b32 v94, 16, v203
    v_and_b32 v95, 0xffff0000, v203
    s_waitcnt vmcnt(1)
    v_mfma_f32_32x32x16_bf16 v[16:31], v[152:155], v[236:239], v[16:31]
    v_max3_u32 v103, v236, v237, v103
    v_xor_b32 v1, 16, v249
    v_xor_b32 v2, 64, v249
    v_xor_b32 v3, 80, v249
    v_xor_b32 v4, 128, v249
    v_mfma_f32_32x32x16_bf16 v[32:47], v[156:159], v[236:239], v[32:47]
    v_max3_u32 v103, v238, v239, v103
    v_xor_b32 v9, 144, v249
    v_xor_b32 v10, 192, v249
    v_xor_b32 v11, 208, v249
    s_waitcnt vmcnt(0)
    v_mfma_f32_32x32x16_bf16 v[16:31], v[160:163], v[240:243], v[16:31]
    v_max3_u32 v103, v240, v241, v103
    v_mfma_f32_32x32x16_bf16 v[32:47], v[164:167], v[240:243], v[32:47]
    v_max3_u32 v103, v242, v243, v103
    v_cmp_eq_u32 vcc, -1, v103
    s_nop 1
    s_cmp_lg_u64 vcc, 0
    s_nop 6
    s_cbranch_scc1 L_refetch
L_fetched:
    ds_write_b128 v249, v[16:19]
    ds_write_b128 v1, v[20:23]
    ds_write_b128 v2, v[24:27]
    ds_write_b128 v3, v[28:31]
    ds_write_b128 v4, v[32:35]
    ds_write_b128 v9, v[36:39]
    ds_write_b128 v10, v[40:43]
    ds_write_b128 v11, v[44:47]
    s_waitcnt lgkmcnt(0)
    s_barrier
    ds_read_b128 v[168:171], v250 offset:0
    ds_read_b128 v[172:175], v6 offset:0
    ds_read_b128 v[176:179], v250 offset:16384
    ds_read_b128 v[180:183], v6 offset:16384
    ds_read_b128 v[184:187], v250 offset:32768
    ds_read_b128 v[188:191], v6 offset:32768
    ds_read_b128 v[192:195], v250 offset:49152
    ds_read_b128 v[196:199], v6 offset:49152
    s_waitcnt lgkmcnt(5)
    v_add_f32 v168, v168, v176
    v_add_f32 v169, v169, v177
    v_add_f32 v170, v170, v178
    v_add_f32 v171, v171, v179
    s_waitcnt lgkmcnt(4)
    v_add_f32 v172, v172, v180
    v_add_f32 v173, v173, v181
    v_add_f32 v174, v174, v182
    v_add_f32 v175, v175, v183
    s_waitcnt lgkmcnt(3)
    v_add_f32 v168, v168, v184
    v_add_f32 v169, v169, v185
    v_add_f32 v170, v170, v186
    v_add_f32 v171, v171, v187
    s_waitcnt lgkmcnt(2)
    v_add_f32 v172, v172, v188
    v_add_f32 v173, v173, v189
    v_add_f32 v174, v174, v190
    v_add_f32 v175, v175, v191
    s_waitcnt lgkmcnt(1)
    v_add_f32 v168, v168, v192
    v_add_f32 v169, v169, v193
    v_add_f32 v170, v170, v194
    v_add_f32 v171, v171, v195
    s_waitcnt lgkmcnt(0)
    v_add_f32 v172, v172, v196
    v_add_f32 v173, v173, v197
    v_add_f32 v174, v174, v198
    v_add_f32 v175, v175, v199
    v_fmac_f32 v88, v168, v80
    v_fmac_f32 v89, v169, v81
    v_fmac_f32 v90, v170, v82
    v_fmac_f32 v91, v171, v83
    v_fmac_f32 v92, v172, v84
    v_fmac_f32 v93, v173, v85
    v_fmac_f32 v94, v174, v86
    v_fmac_f32 v95, v175, v87
    v_cvt_pk_bf16_f32 v200, v88, v89
    v_cvt_pk_bf16_f32 v201, v90, v91
    v_cvt_pk_bf16_f32 v202, v92, v93
    v_cvt_pk_bf16_f32 v203, v94, v95
    buffer_store_dwordx4 v[200:203], v251, s[76:79], s12 offen sc1
    s_or_b32 s14, s2, s3
    s_cmp_lg_u32 s14, 0
    s_cbranch_scc1 L_notag
    s_mov_b32 s14, 131072
    v_mov_b32 v101, s84
    s_mov_b64 exec, 1
    buffer_store_dword v101, v5, s[56:59], s14 offen sc1
    s_mov_b64 exec, -1
    s_nop 0
L_notag:
    s_endpgm
L_refetch:
    s_mov_b32 s86, 0
L_refetch_loop:
    s_add_u32 s14, s11, 0
    buffer_load_dwordx4 v[212:215], v5, s[64:67], s14 offen offset:0 sc1
    s_add_u32 s14, s11, 0
    buffer_load_dwordx4 v[216:219], v5, s[64:67], s14 offen offset:2048 sc1
    s_add_u32 s14, s11, 4096
    buffer_load_dwordx4 v[220:223], v5, s[64:67], s14 offen offset:0 sc1
    s_add_u32 s14, s11, 4096
    buffer_load_dwordx4 v[224:227], v5, s[64:67], s14 offen offset:2048 sc1
    s_add_u32 s14, s11, 8192
    buffer_load_dwordx4 v[228:231], v5, s[64:67], s14 offen offset:0 sc1
    s_add_u32 s14, s11, 8192
    buffer_load_dwordx4 v[232:235], v5, s[64:67], s14 offen offset:2048 sc1
    s_add_u32 s14, s11, 12288
    buffer_load_dwordx4 v[236:239], v5, s[64:67], s14 offen offset:0 sc1
    s_add_u32 s14, s11, 12288
    buffer_load_dwordx4 v[240:243], v5, s[64:67], s14 offen offset:2048 sc1
    s_waitcnt vmcnt(7)
    v_mfma_f32_32x32x16_bf16 v[16:31], v[104:107], v[212:215], 0
    v_max3_u32 v103, v212, v213, 0
    v_mfma_f32_32x32x16_bf16 v[32:47], v[108:111], v[212:215], 0
    v_max3_u32 v103, v214, v215, v103
    s_waitcnt vmcnt(6)
    v_mfma_f32_32x32x16_bf16 v[16:31], v[112:115], v[216:219], v[16:31]
    v_max3_u32 v103, v216, v217, v103
    v_mfma_f32_32x32x16_bf16 v[32:47], v[116:119], v[216:219], v[32:47]
    v_max3_u32 v103, v218, v219, v103
    s_waitcnt vmcnt(5)
    v_mfma_f32_32x32x16_bf16 v[16:31], v[120:123], v[220:223], v[16:31]
    v_max3_u32 v103, v220, v221, v103
    v_mfma_f32_32x32x16_bf16 v[32:47], v[124:127], v[220:223], v[32:47]
    v_max3_u32 v103, v222, v223, v103
    s_waitcnt vmcnt(4)
    v_mfma_f32_32x32x16_bf16 v[16:31], v[128:131], v[224:227], v[16:31]
    v_max3_u32 v103, v224, v225, v103
    v_mfma_f32_32x32x16_bf16 v[32:47], v[132:135], v[224:227], v[32:47]
    v_max3_u32 v103, v226, v227, v103
    s_waitcnt vmcnt(3)
    v_mfma_f32_32x32x16_bf16 v[16:31], v[136:139], v[228:231], v[16:31]
    v_max3_u32 v103, v228, v229, v103
    v_mfma_f32_32x32x16_bf16 v[32:47], v[140:143], v[228:231], v[32:47]
    v_max3_u32 v103, v230, v231, v103
    s_waitcnt vmcnt(2)
    v_mfma_f32_32x32x16_bf16 v[16:31], v[144:147], v[232:235], v[16:31]
    v_max3_u32 v103, v232, v233, v103
    v_mfma_f32_32x32x16_bf16 v[32:47], v[148:151], v[232:235], v[32:47]
    v_max3_u32 v103, v234, v235, v103
    s_waitcnt vmcnt(1)
    v_mfma_f32_32x32x16_bf16 v[16:31], v[152:155], v[236:239], v[16:31]
    v_max3_u32 v103, v236, v237, v103
    v_mfma_f32_32x32x16_bf16 v[32:47], v[156:159], v[236:239], v[32:47]
    v_max3_u32 v103, v238, v239, v103
    s_waitcnt vmcnt(0)
    v_mfma_f32_32x32x16_bf16 v[16:31], v[160:163], v[240:243], v[16:31]
    v_max3_u32 v103, v240, v241, v103
    v_mfma_f32_32x32x16_bf16 v[32:47], v[164:167], v[240:243], v[32:47]
    v_max3_u32 v103, v242, v243, v103
    v_cmp_eq_u32 vcc, -1, v103
    s_add_u32 s86, s86, 1
    s_cmp_ge_u32 s86, 200000
    s_cselect_b64 vcc, 0, vcc
    s_cmp_lg_u64 vcc, 0
    s_nop 5
    s_cbranch_scc1 L_refetch_loop
    s_branch L_fetched
L_spin2:
    s_mov_b32 s86, 0
L_poll2:
    s_mov_b32 s85, 163840
    buffer_load_dword v102, v248, s[56:59], s85 offen sc1
    s_add_u32 s86, s86, 1
    s_waitcnt vmcnt(0)
    v_cmp_eq_u32 vcc, s84, v102
    s_nop 1
    s_cmp_eq_u64 vcc, exec
    s_nop 1
    s_cbranch_scc1 L_poll2_ok
    s_sleep 2
    s_cmp_lt_u32 s86, 200000
    s_cbranch_scc1 L_poll2
L_poll2_ok:
    s_branch L_spin2_ret
L_slow:
    v_and_b32 v6, 15, v0
    v_lshrrev_b32 v7, 5, v0
    v_lshlrev_b32 v6, 4, v6
    v_lshl_add_u32 v6, v7, 8, v6
    v_mov_b32 v101, 0xff800000
    s_mov_b32 s74, 0
    s_nop 0
L_p1:
    buffer_load_dwordx4 v[88:91], v5, s[56:59], s74 offen sc1
    s_waitcnt vmcnt(0)
    v_mfma_f32_32x32x16_bf16 v[16:31], v[88:91], v[84:87], 0
    s_nop 11
    v_max3_f32 v101, v16, v17, v101
    v_max3_f32 v101, v18, v19, v101
    v_max3_f32 v101, v20, v21, v101
    v_max3_f32 v101, v22, v23, v101
    v_max3_f32 v101, v24, v25, v101
    v_max3_f32 v101, v26, v27, v101
    v_max3_f32 v101, v28, v29, v101
    v_max3_f32 v101, v30, v31, v101
    s_add_u32 s74, s74, 1024
    s_cmp_lt_u32 s74, 65536
    s_cbranch_scc1 L_p1
    v_mov_b32 v102, v101
    s_nop 1
    v_permlane32_swap_b32 v101, v102
    v_max_f32 v101, v101, v102
    v_sub_f32 v228, 0, v101
    v_mov_b32 v212, 0
    v_sub_f32 v229, 0, v101
    v_mov_b32 v213, 0
    v_sub_f32 v230, 0, v101
    v_mov_b32 v214, 0
    v_sub_f32 v231, 0, v101
    v_mov_b32 v215, 0
    v_sub_f32 v232, 0, v101
    v_mov_b32 v216, 0
    v_sub_f32 v233, 0, v101
    v_mov_b32 v217, 0
    v_sub_f32 v234, 0, v101
    v_mov_b32 v218, 0
    v_sub_f32 v235, 0, v101
    v_mov_b32 v219, 0
    v_sub_f32 v236, 0, v101
    v_mov_b32 v220, 0
    v_sub_f32 v237, 0, v101
    v_mov_b32 v221, 0
    v_sub_f32 v238, 0, v101
    v_mov_b32 v222, 0
    v_sub_f32 v239, 0, v101
    v_mov_b32 v223, 0
    v_sub_f32 v240, 0, v101
    v_mov_b32 v224, 0
    v_sub_f32 v241, 0, v101
    v_mov_b32 v225, 0
    v_sub_f32 v242, 0, v101
    v_mov_b32 v226, 0
    v_sub_f32 v243, 0, v101
    v_mov_b32 v227, 0
    v_mov_b32 v92, 0x3f803f80
    v_mov_b32 v93, 0x3f803f80
    v_mov_b32 v94, 0x3f803f80
    v_mov_b32 v95, 0x3f803f80
    v_mov_b32 v96, 0x3f803f80
    v_mov_b32 v97, 0x3f803f80
    v_mov_b32 v98, 0x3f803f80
    v_mov_b32 v99, 0x3f803f80
    s_mov_b32 s74, 0
    s_mov_b32 s14, 0x0000ffff
    s_mov_b32 s15, 0x0000ffff
L_p2:
    buffer_load_dwordx4 v[88:91], v5, s[56:59], s74 offen sc1
    s_add_u32 s75, s74, 65536
    s_mov_b64 exec, s[14:15]
    buffer_load_dwordx4 v[92:95], v6, s[56:59], s75 offen sc1
    buffer_load_dwordx4 v[96:99], v6, s[56:59], s75 offen offset:512 sc1
    s_mov_b64 exec, -1
    s_waitcnt vmcnt(2)
    v_mfma_f32_32x32x16_bf16 v[16:31], v[88:91], v[84:87], v[228:243]
    s_nop 11
    v_exp_f32 v16, v16
    v_exp_f32 v17, v17
    v_exp_f32 v18, v18
    v_exp_f32 v19, v19
    v_exp_f32 v20, v20
    v_exp_f32 v21, v21
    v_exp_f32 v22, v22
    v_exp_f32 v23, v23
    v_exp_f32 v24, v24
    v_exp_f32 v25, v25
    v_exp_f32 v26, v26
    v_exp_f32 v27, v27
    v_exp_f32 v28, v28
    v_exp_f32 v29, v29
    v_exp_f32 v30, v30
    v_exp_f32 v31, v31
    s_waitcnt vmcnt(1)
    v_smfmac_f32_32x32x32_bf16 v[212:227], v[92:95], v[16:23], v100
    s_waitcnt vmcnt(0)
    v_smfmac_f32_32x32x32_bf16 v[212:227], v[96:99], v[24:31], v100
    s_add_u32 s74, s74, 1024
    s_cmp_lt_u32 s74, 65536
    s_waitcnt vmcnt(0) lgkmcnt(0)
    s_nop 8
    s_cbranch_scc1 L_p2
    s_branch L_fin
L_end:
    s_endpgm
.section .rodata,"a"
.p2align 6
.amdhsa_kernel recurrent_scan__grouped_kv_mqa__mixer_channel_mlp__prompt_kernel
  .amdhsa_next_free_vgpr 256
  .amdhsa_next_free_sgpr 96
  .amdhsa_accum_offset 256
  .amdhsa_group_segment_fixed_size 0
  .amdhsa_kernarg_size 104
  .amdhsa_user_sgpr_count 2
  .amdhsa_user_sgpr_kernarg_segment_ptr 1
  .amdhsa_system_sgpr_workgroup_id_x 1
  .amdhsa_float_denorm_mode_32 3
.end_amdhsa_kernel
```
